```python
import torch

def _softmax(x, axis=-1):
    return torch.softmax(x, dim=axis)
def _gelu(x):
    return torch.nn.functional.gelu(x, approximate="tanh")
def _silu(x):
    return torch.nn.functional.silu(x)
def _sigmoid(x):
    return torch.sigmoid(x)
def _layernorm(x, axis=-1, eps=1e-5):
    m = x.mean(dim=axis, keepdim=True)
    v = x.var(dim=axis, keepdim=True, unbiased=False)
    return (x - m) / torch.sqrt(v + eps)
def _scatter_add(tgt, idx, src, axis=0):
    return tgt.clone().index_add_(axis, idx, src)
def _segment_sum(src, seg, n):
    out = torch.zeros((n,) + src.shape[1:], dtype=src.dtype)
    return out.index_add_(0, seg, src)
def _pad(x, pw):
    flat = tuple(v for pair in reversed(pw) for v in pair)
    return torch.nn.functional.pad(x, flat)

kernel_name = 'gated_mix__gqa_block_cached__glu_gated_glu__decode'

def setup_inputs():

    _w = (lambda a: (lambda t: t.to(torch.bfloat16) if t.is_floating_point() else t)(torch.as_tensor(a)))
    def _A_setup():
        B, Sq, D = 4, 1, 512
        Hq, Hkv, Sk, Dh = 32, 32, 4096, 128
        assert Hq % Hkv == 0, (Hq, Hkv)
        return {
            "x": _w((lambda *s: torch.randn(*s, dtype=torch.bfloat16) * 0.05)(B, Sq, D)),
            "k_cache": _w((lambda *s: torch.randn(*s, dtype=torch.bfloat16) * 6.4)(B, Hkv, Sk, Dh)),
            "v_cache": _w((lambda *s: torch.randn(*s, dtype=torch.bfloat16) * 0.4)(B, Hkv, Sk, Dh)),
            "wq": _w((lambda *s: torch.randn(*s, dtype=torch.bfloat16) * 6.4)(D, Hq * Dh) * (D ** -0.5)),
            "wo": _w((lambda *s: torch.randn(*s, dtype=torch.bfloat16) * 0.4)(Hq * Dh, D) * ((Hq * Dh) ** -0.5)),
        }
    _A_in = _A_setup()

    def _B_setup():
        B, S, D, F = 4, 1, 512, 1376
        return {
            "x": _w((lambda *s: torch.randn(*s, dtype=torch.bfloat16) * 0.05)(B, S, D)),
            "w_gate": _w((lambda *s: torch.randn(*s, dtype=torch.bfloat16) * 0.4)(D, F)),
            "w_up": _w((lambda *s: torch.randn(*s, dtype=torch.bfloat16) * 0.05)(D, F)),
            "w_down": _w((lambda *s: torch.randn(*s, dtype=torch.bfloat16) * 0.05)(F, D)),
        }
    _B_in = _B_setup()

    return {
        "A_x": _A_in["x"],
        "A_k_cache": _A_in["k_cache"],
        "A_v_cache": _A_in["v_cache"],
        "A_wq": _A_in["wq"],
        "A_wo": _A_in["wo"],
        "B_x": _B_in["x"],
        "B_w_gate": _B_in["w_gate"],
        "B_w_up": _B_in["w_up"],
        "B_w_down": _B_in["w_down"],
        "gate_w": _w((lambda *s: torch.randn(*s, dtype=torch.bfloat16) * 0.05)(512) * 16.0),
    }

def reference(A_x, A_k_cache, A_v_cache, A_wq, A_wo, B_x, B_w_gate, B_w_up, B_w_down, gate_w):
    def _A_ref(x, k_cache, v_cache, wq, wo):
        B, Sq, D = x.shape
        Hq, Dh = 32, 128
        Hkv = k_cache.shape[1]
        rep = Hq // Hkv
        q = (lambda x, *d: x.permute(*d))((x @ wq).reshape(B, Sq, Hq, Dh), 0, 2, 1, 3)
        k = (lambda x, n, axis: torch.repeat_interleave(x, n, dim=axis))(k_cache, rep, axis=1)
        v = (lambda x, n, axis: torch.repeat_interleave(x, n, dim=axis))(v_cache, rep, axis=1)
        scores = torch.einsum("bhqd,bhkd->bhqk", q, k) * (Dh ** -0.5)
        p = _softmax(scores, axis=-1)
        o = torch.einsum("bhqk,bhkd->bhqd", p, v)
        return (lambda x, *d: x.permute(*d))(o, 0, 2, 1, 3).reshape(B, Sq, Hq * Dh) @ wo

    def _B_ref(x, w_gate, w_up, w_down):
        g = torch.einsum("bsd,df->bsf", x, w_gate)
        u = torch.einsum("bsd,df->bsf", x, w_up)
        h = _sigmoid(g) * u
        return torch.einsum("bsf,fd->bsd", h, w_down)

    x = A_x
    g = _sigmoid((x * gate_w).sum(-1, keepdims=True))
    a = _A_ref(x, A_k_cache, A_v_cache, A_wq, A_wo)
    b = _B_ref(x, B_w_gate, B_w_up, B_w_down)
    return g * a + (1 - g) * b
```

```asm
; @launch kernel=attn_kernel grid=(256,1,1) block=(704,1,1) lds=162304
.amdgcn_target "amdgcn-amd-amdhsa--gfx950"
.text
.globl attn_kernel
.p2align 8
.type attn_kernel,@function
attn_kernel:
    s_cmp_ge_u32 s2, 256
    s_cbranch_scc1 LA_end
    s_load_dwordx16 s[16:31], s[0:1], 0
    s_load_dwordx8 s[32:39], s[0:1], 64
    s_load_dwordx2 s[40:41], s[0:1], 96
    v_lshrrev_b32 v1, 6, v0
    s_nop 0
    v_readfirstlane_b32 s3, v1
    s_cmp_eq_u32 s3, 0
    s_cbranch_scc1 LA_tk
    s_getpc_b64 s[64:65]
LA_pc:
    s_mov_b32 s66, LB_end-LA_pc
    s_mov_b32 s67, 0x20000
    v_lshlrev_b32 v2, 6, v0
    buffer_load_dword v39, v2, s[64:67], 0 offen
    v_and_b32 v0, 63, v0
    v_lshlrev_b32 v3, 2, v0
    v_mov_b32 v2, 0
    v_add_u32 v3, 147456, v3
    ds_write_b32 v3, v2
    v_mov_b32 v4, 151936
    s_waitcnt lgkmcnt(0)
    s_getreg_b32 s4, hwreg(HW_REG_XCC_ID)
    s_getreg_b32 s5, hwreg(HW_REG_HW_ID)
    s_and_b32 s4, s4, 7
    s_bfe_u32 s6, s5, 0x2000d
    s_bfe_u32 s5, s5, 0x30008
    s_lshl_b32 s6, s6, 3
    s_add_u32 s5, s5, s6
    s_cmp_lt_u32 s3, 9
    s_cbranch_scc1 LA_pwo
    s_cmp_eq_u32 s3, 9
    s_cselect_b32 s48, s28, s30
    s_cselect_b32 s49, s29, s31
    s_mov_b32 s50, 1409024
    s_mov_b32 s51, 0x20000
    s_mul_i32 s6, s5, 44032
    s_lshl_b32 s7, s4, 7
    s_add_u32 s6, s6, s7
    v_lshrrev_b32 v5, 2, v0
    v_mul_u32_u24 v5, 2752, v5
    v_and_b32 v6, 3, v0
    v_lshl_add_u32 v5, v6, 10, v5
    s_cmp_lt_u32 s4, 6
    s_mov_b32 s8, 0x33333333
    s_mov_b32 s9, 0x77777777
    s_cselect_b32 s8, s9, s8
    s_mov_b32 s9, s8
    s_mov_b64 exec, s[8:9]
    buffer_load_dword v37, v5, s[48:51], s6 offen
    buffer_load_dword v38, v5, s[48:51], s6 offen offset:124
    s_mov_b64 exec, -1
    s_branch LA_nopwq
LA_pwo:
    s_mov_b32 s7, s5
    s_mov_b32 s51, 0x20000
    s_mov_b32 s50, 0x00400000
LA_nopwq:
    s_barrier
    ds_read_b32 v5, v4
    s_waitcnt lgkmcnt(0)
    v_readfirstlane_b32 s2, v5
    s_branch LA_tk_done
LA_tk:
    s_getreg_b32 s4, hwreg(HW_REG_XCC_ID)
    s_and_b32 s4, s4, 7
    s_movk_i32 s62, 256
    s_mov_b32 s63, 0x20000
    s_mov_b32 s9, 0
    v_mov_b32 v6, 151936
    s_mov_b64 exec, 1
    s_waitcnt lgkmcnt(0)
    s_mov_b32 s60, s38
    s_mov_b32 s61, s39
LA_tk_loop:
    s_lshl_b32 s5, s4, 5
    v_mov_b32 v4, 1
    v_mov_b32 v5, s5
    buffer_atomic_add v4, v5, s[60:63], 0 offen sc0
LA_tk_wait:
    s_waitcnt vmcnt(0)
    v_readfirstlane_b32 s5, v4
    s_cmp_lt_u32 s5, 32
    s_cbranch_scc1 LA_tk_got
    s_add_u32 s4, s4, 1
    s_and_b32 s4, s4, 7
    s_add_u32 s9, s9, 1
    s_cmp_lt_u32 s9, 8
    s_cbranch_scc1 LA_tk_loop
    s_movk_i32 s5, 64
LA_tk_got:
    s_and_b32 s2, s5, 3
    s_lshl_b32 s2, s2, 3
    s_or_b32 s2, s2, s4
    s_bfe_u32 s4, s5, 0x10004
    s_lshl_b32 s4, s4, 5
    s_or_b32 s2, s2, s4
    s_bfe_u32 s4, s5, 0x20002
    s_lshl_b32 s4, s4, 6
    s_or_b32 s2, s2, s4
    s_and_b32 s4, s5, 64
    s_lshl_b32 s4, s4, 2
    s_or_b32 s2, s2, s4
    v_mov_b32 v4, s2
    ds_write_b32 v6, v4
    s_mov_b64 exec, -1
    s_waitcnt lgkmcnt(0)
    s_barrier
LA_tk_done:
    s_cmp_ge_u32 s2, 256
    s_cbranch_scc1 LA_end
    s_and_b32 s4, s2, 7
    s_bfe_u32 s6, s2, 0x20003
    s_lshl_b32 s4, s4, 2
    s_add_u32 s6, s6, s4
    s_lshr_b32 s7, s2, 6
    s_bfe_u32 s8, s2, 0x10005
    s_lshl_b32 s5, s7, 5
    s_add_u32 s5, s5, s6
    s_cmp_lt_u32 s5, 86
    s_cselect_b32 s4, 3, 0
    s_cmp_lt_u32 s5, 64
    s_cselect_b32 s4, 2, s4
    s_sub_u32 s78, 128, s4
    s_add_u32 s79, s4, 128
    s_cmp_eq_u32 s8, 0
    s_cselect_b32 s79, s78, s79
    s_cselect_b32 s78, 0, s78
    v_lshlrev_b32 v1, 4, v0
    s_mov_b32 s47, 0x20000
    s_mov_b32 s51, 0x20000
    s_cmp_lg_u32 s3, 0
    s_cbranch_scc1 LA_cons
    s_setprio 3
    s_lshl_b32 s10, s5, 20
    s_lshl_b32 s4, s78, 12
    s_add_u32 s10, s10, s4
    s_mov_b32 s44, s18
    s_mov_b32 s45, s19
    s_mov_b32 s46, 0x08000000
    s_mov_b32 s48, s20
    s_mov_b32 s49, s21
    s_mov_b32 s50, 0x08000000
    s_mov_b32 s12, 0
    s_mov_b32 s13, 0
    s_mov_b32 s9, 0
    v_mov_b32 v4, 147456
    s_movk_i32 s15, 18
    s_sub_u32 s11, s79, 0
    s_mov_b32 s64, 0
LL_loop:
    s_mov_b32 m0, s12
    s_add_u32 s14, s12, 4096
    buffer_load_dwordx4 v1, s[44:47], s10 offen offset:0 nt lds
    buffer_load_dwordx4 v1, s[44:47], s10 offen offset:1024 nt lds
    buffer_load_dwordx4 v1, s[44:47], s10 offen offset:2048 nt lds
    buffer_load_dwordx4 v1, s[44:47], s10 offen offset:3072 nt lds
    s_mov_b32 m0, s14
    s_add_u32 s12, s12, 8192
    buffer_load_dwordx4 v1, s[48:51], s10 offen offset:0 nt lds
    buffer_load_dwordx4 v1, s[48:51], s10 offen offset:1024 nt lds
    buffer_load_dwordx4 v1, s[48:51], s10 offen offset:2048 nt lds
    buffer_load_dwordx4 v1, s[48:51], s10 offen offset:3072 nt lds
    s_cmp_eq_u32 s12, 147456
    s_cselect_b32 s12, 0, s12
    s_add_u32 s10, s10, 4096
    s_add_u32 s13, s13, 1
    s_sub_u32 s14, s13, 18
    s_and_b32 s5, s14, 7
    s_lshl_b32 s5, s5, 2
    s_add_u32 s5, s5, 147460
    v_mov_b32 v5, s5
    ds_read_b32 v7, v5
    ds_read_b32 v8, v4 offset:128
    s_cmp_lg_u32 s64, 0
    s_cbranch_scc1 LL_lv1
    s_sub_u32 s4, s13, 2
    s_max_i32 s9, s9, s4
    v_mov_b32 v6, s9
    s_waitcnt vmcnt(16)
    s_branch LL_pub
LL_lv1:
    s_cmp_lg_u32 s64, 1
    s_cbranch_scc1 LL_lv2
    s_sub_u32 s4, s13, 3
    s_max_i32 s9, s9, s4
    v_mov_b32 v6, s9
    s_waitcnt vmcnt(20)
    s_branch LL_pub
LL_lv2:
    s_sub_u32 s4, s13, 3
    s_max_i32 s9, s9, s4
    v_mov_b32 v6, s9
    s_waitcnt vmcnt(24)
LL_pub:
    s_waitcnt lgkmcnt(0)
    v_readfirstlane_b32 s64, v8
    ds_write_b32 v4, v6
    s_cmp_ge_u32 s13, s79
    s_cbranch_scc1 LL_fin
    s_cmp_lt_u32 s13, s15
    s_cbranch_scc1 LL_loop
    s_lshr_b32 s14, s14, 3
    v_readfirstlane_b32 s4, v7
    s_cmp_gt_u32 s4, s14
    s_cbranch_scc1 LL_loop
    s_mov_b32 s9, s13
    v_mov_b32 v6, s13
    s_waitcnt vmcnt(0)
    ds_write_b32 v4, v6
LL_spin:
    s_sleep 1
    ds_read_b32 v7, v5
    s_waitcnt lgkmcnt(0)
    v_readfirstlane_b32 s4, v7
    s_cmp_gt_u32 s4, s14
    s_cbranch_scc1 LL_loop
    s_branch LL_spin
LL_fin:
    s_sub_u32 s4, s79, 2
    s_max_i32 s9, s9, s4
    v_mov_b32 v6, s9
    s_waitcnt vmcnt(16)
    ds_write_b32 v4, v6
    s_sub_u32 s4, s79, 1
    s_max_i32 s9, s9, s4
    v_mov_b32 v6, s9
    s_waitcnt vmcnt(8)
    ds_write_b32 v4, v6
    s_sub_u32 s4, s79, 0
    s_max_i32 s9, s9, s4
    v_mov_b32 v6, s9
    s_waitcnt vmcnt(0)
    ds_write_b32 v4, v6
    s_branch LA_end2
LA_cons:
    s_mov_b32 s42, 0xffff0000
    s_mov_b32 s69, 0x3fb8aa3b
    s_mov_b32 s55, 0x20000
    s_mov_b32 s59, 0x20000
    s_mov_b32 s63, 0x20000
    s_cmp_lt_u32 s5, 64
    s_cselect_b32 s75, 2, 0
    s_cmp_eq_u32 s8, 0
    s_cselect_b32 s75, 1, s75
    s_cmp_ge_u32 s5, 86
    s_cselect_b32 s75, 0, s75
    s_cmp_ge_u32 s5, 88
    s_cselect_b32 s75, 3, s75
    s_and_b32 s76, s2, 7
    s_cmp_lt_u32 s5, 96
    s_cselect_b32 s4, 2, 0
    s_add_u32 s76, s76, s4
    s_and_b32 s77, s6, 3
    s_lshl_b32 s77, s77, 1
    s_add_u32 s77, s77, s8
    s_cmp_eq_u32 s3, 9
    s_cbranch_scc1 LA_ffn
    s_cmp_eq_u32 s3, 10
    s_cbranch_scc1 LA_mon
    s_sub_u32 s9, s3, 1
    v_lshrrev_b32 v20, 4, v0
    v_and_b32 v21, 15, v0
    v_lshlrev_b32 v2, 14, v20
    v_lshl_add_u32 v2, v21, 4, v2
    v_lshlrev_b32 v3, 2, v20
    v_lshl_add_u32 v3, v21, 4, v3
    s_lshl_b32 s4, s7, 10
    s_lshl_b32 s5, s9, 7
    s_add_u32 s4, s4, s5
    s_lshl_b32 s11, s9, 19
    s_lshl_b32 s12, s6, 8
    s_add_u32 s11, s11, s12
    s_mov_b32 s48, s22
    s_mov_b32 s49, s23
    s_mov_b32 s50, 4194304
    s_mov_b32 s56, s16
    s_mov_b32 s57, s17
    s_mov_b32 s58, 4096
    buffer_load_dword v16, v3, s[56:59], s4 offen
    buffer_load_dwordx4 v[40:43], v2, s[48:51], s11 offen
    s_add_u32 s12, s11, 8192
    buffer_load_dwordx4 v[44:47], v2, s[48:51], s12 offen
    s_add_u32 s11, s11, 65536
    buffer_load_dwordx4 v[48:51], v2, s[48:51], s11 offen
    s_add_u32 s12, s11, 8192
    buffer_load_dwordx4 v[52:55], v2, s[48:51], s12 offen
    s_add_u32 s11, s11, 65536
    buffer_load_dwordx4 v[56:59], v2, s[48:51], s11 offen
    s_add_u32 s12, s11, 8192
    buffer_load_dwordx4 v[60:63], v2, s[48:51], s12 offen
    s_add_u32 s11, s11, 65536
    buffer_load_dwordx4 v[64:67], v2, s[48:51], s11 offen
    s_add_u32 s12, s11, 8192
    buffer_load_dwordx4 v[68:71], v2, s[48:51], s12 offen
    s_add_u32 s11, s11, 65536
    buffer_load_dwordx4 v[72:75], v2, s[48:51], s11 offen
    s_add_u32 s12, s11, 8192
    buffer_load_dwordx4 v[76:79], v2, s[48:51], s12 offen
    s_add_u32 s11, s11, 65536
    buffer_load_dwordx4 v[80:83], v2, s[48:51], s11 offen
    s_add_u32 s12, s11, 8192
    buffer_load_dwordx4 v[84:87], v2, s[48:51], s12 offen
    s_add_u32 s11, s11, 65536
    buffer_load_dwordx4 v[88:91], v2, s[48:51], s11 offen
    s_add_u32 s12, s11, 8192
    buffer_load_dwordx4 v[92:95], v2, s[48:51], s12 offen
    s_add_u32 s11, s11, 65536
    buffer_load_dwordx4 v[96:99], v2, s[48:51], s11 offen
    s_add_u32 s12, s11, 8192
    buffer_load_dwordx4 v[100:103], v2, s[48:51], s12 offen
    s_mov_b32 s68, 0x3db504f3
    s_mov_b32 s70, 0x05040100
    s_mov_b32 s71, 0x07060302
    s_mov_b32 s52, s24
    s_mov_b32 s53, s25
    s_mov_b32 s54, 4194304
    s_mov_b32 s60, s40
    s_mov_b32 s61, s41
    s_mov_b32 s62, 526336
    v_and_b32 v22, 1, v20
    v_lshlrev_b32 v22, 1, v22
    v_lshrrev_b32 v23, 1, v20
    v_or_b32 v22, v22, v23
    v_lshl_add_u32 v22, v21, 3, v22
    v_lshlrev_b32 v22, 2, v22
    s_lshl_b32 s4, s9, 9
    s_add_u32 s4, s4, 147712
    v_add_u32 v19, s4, v22
    v_mov_b32 v136, 147456
    v_mov_b32 v139, 1
    s_lshl_b32 s4, s9, 13
    v_add_u32 v137, s4, v1
    s_lshl_b32 s4, s9, 2
    s_add_u32 s4, s4, 147460
    v_mov_b32 v138, s4
    v_mov_b32 v8, 0
    v_mov_b32 v9, 0
    v_mov_b32 v10, 0
    v_mov_b32 v11, 0
    v_mov_b32 v12, 0
    v_mov_b32 v13, 0
    v_mov_b32 v14, 0
    v_mov_b32 v15, 0
    s_waitcnt vmcnt(14)
    v_perm_b32 v24, v44, v40, s70
    v_perm_b32 v25, v44, v40, s71
    v_perm_b32 v26, v45, v41, s70
    v_perm_b32 v27, v45, v41, s71
    v_perm_b32 v28, v46, v42, s70
    v_perm_b32 v29, v46, v42, s71
    v_perm_b32 v30, v47, v43, s70
    v_perm_b32 v31, v47, v43, s71
    v_dot2c_f32_bf16_dpp v8, v16, v24 row_newbcast:0 row_mask:0xf bank_mask:0xf
    v_dot2c_f32_bf16_dpp v9, v16, v25 row_newbcast:0 row_mask:0xf bank_mask:0xf
    v_dot2c_f32_bf16_dpp v10, v16, v26 row_newbcast:0 row_mask:0xf bank_mask:0xf
    v_dot2c_f32_bf16_dpp v11, v16, v27 row_newbcast:0 row_mask:0xf bank_mask:0xf
    v_dot2c_f32_bf16_dpp v12, v16, v28 row_newbcast:0 row_mask:0xf bank_mask:0xf
    v_dot2c_f32_bf16_dpp v13, v16, v29 row_newbcast:0 row_mask:0xf bank_mask:0xf
    v_dot2c_f32_bf16_dpp v14, v16, v30 row_newbcast:0 row_mask:0xf bank_mask:0xf
    v_dot2c_f32_bf16_dpp v15, v16, v31 row_newbcast:0 row_mask:0xf bank_mask:0xf
    s_waitcnt vmcnt(12)
    v_perm_b32 v32, v52, v48, s70
    v_perm_b32 v33, v52, v48, s71
    v_perm_b32 v34, v53, v49, s70
    v_perm_b32 v35, v53, v49, s71
    v_perm_b32 v36, v54, v50, s70
    v_perm_b32 v37, v54, v50, s71
    v_perm_b32 v38, v55, v51, s70
    v_perm_b32 v39, v55, v51, s71
    v_dot2c_f32_bf16_dpp v8, v16, v32 row_newbcast:1 row_mask:0xf bank_mask:0xf
    v_dot2c_f32_bf16_dpp v9, v16, v33 row_newbcast:1 row_mask:0xf bank_mask:0xf
    v_dot2c_f32_bf16_dpp v10, v16, v34 row_newbcast:1 row_mask:0xf bank_mask:0xf
    v_dot2c_f32_bf16_dpp v11, v16, v35 row_newbcast:1 row_mask:0xf bank_mask:0xf
    v_dot2c_f32_bf16_dpp v12, v16, v36 row_newbcast:1 row_mask:0xf bank_mask:0xf
    v_dot2c_f32_bf16_dpp v13, v16, v37 row_newbcast:1 row_mask:0xf bank_mask:0xf
    v_dot2c_f32_bf16_dpp v14, v16, v38 row_newbcast:1 row_mask:0xf bank_mask:0xf
    v_dot2c_f32_bf16_dpp v15, v16, v39 row_newbcast:1 row_mask:0xf bank_mask:0xf
    s_waitcnt vmcnt(10)
    v_perm_b32 v24, v60, v56, s70
    v_perm_b32 v25, v60, v56, s71
    v_perm_b32 v26, v61, v57, s70
    v_perm_b32 v27, v61, v57, s71
    v_perm_b32 v28, v62, v58, s70
    v_perm_b32 v29, v62, v58, s71
    v_perm_b32 v30, v63, v59, s70
    v_perm_b32 v31, v63, v59, s71
    v_dot2c_f32_bf16_dpp v8, v16, v24 row_newbcast:2 row_mask:0xf bank_mask:0xf
    v_dot2c_f32_bf16_dpp v9, v16, v25 row_newbcast:2 row_mask:0xf bank_mask:0xf
    v_dot2c_f32_bf16_dpp v10, v16, v26 row_newbcast:2 row_mask:0xf bank_mask:0xf
    v_dot2c_f32_bf16_dpp v11, v16, v27 row_newbcast:2 row_mask:0xf bank_mask:0xf
    v_dot2c_f32_bf16_dpp v12, v16, v28 row_newbcast:2 row_mask:0xf bank_mask:0xf
    v_dot2c_f32_bf16_dpp v13, v16, v29 row_newbcast:2 row_mask:0xf bank_mask:0xf
    v_dot2c_f32_bf16_dpp v14, v16, v30 row_newbcast:2 row_mask:0xf bank_mask:0xf
    v_dot2c_f32_bf16_dpp v15, v16, v31 row_newbcast:2 row_mask:0xf bank_mask:0xf
    s_waitcnt vmcnt(8)
    v_perm_b32 v32, v68, v64, s70
    v_perm_b32 v33, v68, v64, s71
    v_perm_b32 v34, v69, v65, s70
    v_perm_b32 v35, v69, v65, s71
    v_perm_b32 v36, v70, v66, s70
    v_perm_b32 v37, v70, v66, s71
    v_perm_b32 v38, v71, v67, s70
    v_perm_b32 v39, v71, v67, s71
    v_dot2c_f32_bf16_dpp v8, v16, v32 row_newbcast:3 row_mask:0xf bank_mask:0xf
    v_dot2c_f32_bf16_dpp v9, v16, v33 row_newbcast:3 row_mask:0xf bank_mask:0xf
    v_dot2c_f32_bf16_dpp v10, v16, v34 row_newbcast:3 row_mask:0xf bank_mask:0xf
    v_dot2c_f32_bf16_dpp v11, v16, v35 row_newbcast:3 row_mask:0xf bank_mask:0xf
    v_dot2c_f32_bf16_dpp v12, v16, v36 row_newbcast:3 row_mask:0xf bank_mask:0xf
    v_dot2c_f32_bf16_dpp v13, v16, v37 row_newbcast:3 row_mask:0xf bank_mask:0xf
    v_dot2c_f32_bf16_dpp v14, v16, v38 row_newbcast:3 row_mask:0xf bank_mask:0xf
    v_dot2c_f32_bf16_dpp v15, v16, v39 row_newbcast:3 row_mask:0xf bank_mask:0xf
    s_waitcnt vmcnt(6)
    v_perm_b32 v24, v76, v72, s70
    v_perm_b32 v25, v76, v72, s71
    v_perm_b32 v26, v77, v73, s70
    v_perm_b32 v27, v77, v73, s71
    v_perm_b32 v28, v78, v74, s70
    v_perm_b32 v29, v78, v74, s71
    v_perm_b32 v30, v79, v75, s70
    v_perm_b32 v31, v79, v75, s71
    v_dot2c_f32_bf16_dpp v8, v16, v24 row_newbcast:4 row_mask:0xf bank_mask:0xf
    v_dot2c_f32_bf16_dpp v9, v16, v25 row_newbcast:4 row_mask:0xf bank_mask:0xf
    v_dot2c_f32_bf16_dpp v10, v16, v26 row_newbcast:4 row_mask:0xf bank_mask:0xf
    v_dot2c_f32_bf16_dpp v11, v16, v27 row_newbcast:4 row_mask:0xf bank_mask:0xf
    v_dot2c_f32_bf16_dpp v12, v16, v28 row_newbcast:4 row_mask:0xf bank_mask:0xf
    v_dot2c_f32_bf16_dpp v13, v16, v29 row_newbcast:4 row_mask:0xf bank_mask:0xf
    v_dot2c_f32_bf16_dpp v14, v16, v30 row_newbcast:4 row_mask:0xf bank_mask:0xf
    v_dot2c_f32_bf16_dpp v15, v16, v31 row_newbcast:4 row_mask:0xf bank_mask:0xf
    s_waitcnt vmcnt(4)
    v_perm_b32 v32, v84, v80, s70
    v_perm_b32 v33, v84, v80, s71
    v_perm_b32 v34, v85, v81, s70
    v_perm_b32 v35, v85, v81, s71
    v_perm_b32 v36, v86, v82, s70
    v_perm_b32 v37, v86, v82, s71
    v_perm_b32 v38, v87, v83, s70
    v_perm_b32 v39, v87, v83, s71
    v_dot2c_f32_bf16_dpp v8, v16, v32 row_newbcast:5 row_mask:0xf bank_mask:0xf
    v_dot2c_f32_bf16_dpp v9, v16, v33 row_newbcast:5 row_mask:0xf bank_mask:0xf
    v_dot2c_f32_bf16_dpp v10, v16, v34 row_newbcast:5 row_mask:0xf bank_mask:0xf
    v_dot2c_f32_bf16_dpp v11, v16, v35 row_newbcast:5 row_mask:0xf bank_mask:0xf
    v_dot2c_f32_bf16_dpp v12, v16, v36 row_newbcast:5 row_mask:0xf bank_mask:0xf
    v_dot2c_f32_bf16_dpp v13, v16, v37 row_newbcast:5 row_mask:0xf bank_mask:0xf
    v_dot2c_f32_bf16_dpp v14, v16, v38 row_newbcast:5 row_mask:0xf bank_mask:0xf
    v_dot2c_f32_bf16_dpp v15, v16, v39 row_newbcast:5 row_mask:0xf bank_mask:0xf
    s_waitcnt vmcnt(2)
    v_perm_b32 v24, v92, v88, s70
    v_perm_b32 v25, v92, v88, s71
    v_perm_b32 v26, v93, v89, s70
    v_perm_b32 v27, v93, v89, s71
    v_perm_b32 v28, v94, v90, s70
    v_perm_b32 v29, v94, v90, s71
    v_perm_b32 v30, v95, v91, s70
    v_perm_b32 v31, v95, v91, s71
    v_dot2c_f32_bf16_dpp v8, v16, v24 row_newbcast:6 row_mask:0xf bank_mask:0xf
    v_dot2c_f32_bf16_dpp v9, v16, v25 row_newbcast:6 row_mask:0xf bank_mask:0xf
    v_dot2c_f32_bf16_dpp v10, v16, v26 row_newbcast:6 row_mask:0xf bank_mask:0xf
    v_dot2c_f32_bf16_dpp v11, v16, v27 row_newbcast:6 row_mask:0xf bank_mask:0xf
    v_dot2c_f32_bf16_dpp v12, v16, v28 row_newbcast:6 row_mask:0xf bank_mask:0xf
    v_dot2c_f32_bf16_dpp v13, v16, v29 row_newbcast:6 row_mask:0xf bank_mask:0xf
    v_dot2c_f32_bf16_dpp v14, v16, v30 row_newbcast:6 row_mask:0xf bank_mask:0xf
    v_dot2c_f32_bf16_dpp v15, v16, v31 row_newbcast:6 row_mask:0xf bank_mask:0xf
    s_waitcnt vmcnt(0)
    v_perm_b32 v32, v100, v96, s70
    v_perm_b32 v33, v100, v96, s71
    v_perm_b32 v34, v101, v97, s70
    v_perm_b32 v35, v101, v97, s71
    v_perm_b32 v36, v102, v98, s70
    v_perm_b32 v37, v102, v98, s71
    v_perm_b32 v38, v103, v99, s70
    v_perm_b32 v39, v103, v99, s71
    v_dot2c_f32_bf16_dpp v8, v16, v32 row_newbcast:7 row_mask:0xf bank_mask:0xf
    v_dot2c_f32_bf16_dpp v9, v16, v33 row_newbcast:7 row_mask:0xf bank_mask:0xf
    v_dot2c_f32_bf16_dpp v10, v16, v34 row_newbcast:7 row_mask:0xf bank_mask:0xf
    v_dot2c_f32_bf16_dpp v11, v16, v35 row_newbcast:7 row_mask:0xf bank_mask:0xf
    v_dot2c_f32_bf16_dpp v12, v16, v36 row_newbcast:7 row_mask:0xf bank_mask:0xf
    v_dot2c_f32_bf16_dpp v13, v16, v37 row_newbcast:7 row_mask:0xf bank_mask:0xf
    v_dot2c_f32_bf16_dpp v14, v16, v38 row_newbcast:7 row_mask:0xf bank_mask:0xf
    v_dot2c_f32_bf16_dpp v15, v16, v39 row_newbcast:7 row_mask:0xf bank_mask:0xf
    v_permlane32_swap_b32 v8, v9
    v_permlane32_swap_b32 v10, v11
    v_permlane32_swap_b32 v12, v13
    v_permlane32_swap_b32 v14, v15
    v_add_f32 v8, v8, v9
    v_add_f32 v10, v10, v11
    v_add_f32 v12, v12, v13
    v_add_f32 v14, v14, v15
    v_permlane16_swap_b32 v8, v10
    s_nop 0
    v_permlane16_swap_b32 v12, v14
    v_add_f32 v8, v8, v10
    v_add_f32 v12, v12, v14
    ds_write_b32 v19, v8
    ds_write_b32 v19, v12 offset:16
    v_lshlrev_b32 v20, 3, v0
    v_add_u32 v20, 147712, v20
    s_waitcnt lgkmcnt(0)
    s_mov_b64 exec, 1
    ds_add_u32 v136, v139 offset:64
    s_mov_b64 exec, -1
LB_spinq:
    ds_read_b32 v23, v136 offset:64
    s_waitcnt lgkmcnt(0)
    v_readfirstlane_b32 s14, v23
    s_cmp_lt_u32 s14, 8
    s_cbranch_scc1 LB_spinq
    ds_read_b64 v[24:25], v20 offset:0
    ds_read_b64 v[26:27], v20 offset:512
    ds_read_b64 v[28:29], v20 offset:1024
    ds_read_b64 v[30:31], v20 offset:1536
    ds_read_b64 v[32:33], v20 offset:2048
    ds_read_b64 v[34:35], v20 offset:2560
    ds_read_b64 v[36:37], v20 offset:3072
    ds_read_b64 v[38:39], v20 offset:3584
    s_lshl_b32 s4, s9, 8
    s_add_u32 s4, s4, 152064
    v_lshlrev_b32 v21, 2, v0
    v_add_u32 v21, s4, v21
    v_and_b32 v22, 15, v0
    v_lshlrev_b32 v22, 4, v22
    v_add_u32 v22, s4, v22
    s_waitcnt lgkmcnt(0)
    v_add_f32 v24, v24, v26
    v_add_f32 v25, v25, v27
    v_add_f32 v28, v28, v30
    v_add_f32 v29, v29, v31
    v_add_f32 v32, v32, v34
    v_add_f32 v33, v33, v35
    v_add_f32 v36, v36, v38
    v_add_f32 v37, v37, v39
    v_add_f32 v24, v24, v28
    v_add_f32 v25, v25, v29
    v_add_f32 v32, v32, v36
    v_add_f32 v33, v33, v37
    v_add_f32 v24, v24, v32
    v_add_f32 v25, v25, v33
    v_cvt_pk_bf16_f32 v23, v24, v25
    ds_write_b32 v21, v23
    s_waitcnt lgkmcnt(0)
    ds_read_b128 v[4:7], v22
    v_mov_b32 v8, 0
    v_mov_b32 v9, 0
    v_mov_b32 v10, 0
    v_mov_b32 v11, 0
    v_mov_b32 v12, 0
    v_mov_b32 v13, 0
    v_mov_b32 v14, 0
    v_mov_b32 v15, 0
    v_mov_b32 v17, 0xff800000
    v_mov_b32 v18, 0
    s_lshl_b32 s43, s6, 17
    s_lshl_b32 s5, s9, 7
    s_add_u32 s43, s43, s5
    v_lshrrev_b32 v22, 4, v0
    v_and_b32 v23, 15, v0
    v_lshlrev_b32 v142, 15, v22
    v_lshl_add_u32 v142, v23, 3, v142
    v_and_b32 v143, 1, v22
    v_lshlrev_b32 v143, 1, v143
    v_lshrrev_b32 v22, 1, v22
    v_or_b32 v143, v143, v22
    v_lshl_add_u32 v143, v23, 2, v143
    v_lshlrev_b32 v143, 2, v143
    v_and_b32 v144, 12, v143
    v_lshlrev_b32 v144, 1, v144
    s_movk_i32 s67, 0xff
    s_lshl_b32 s5, s7, 6
    s_lshl_b32 s12, s6, 1
    s_add_u32 s5, s5, s12
    s_add_u32 s5, s5, s8
    s_lshl_b32 s65, s5, 3
    s_add_u32 s65, s65, 524288
    s_lshl_b32 s64, s5, 11
    s_lshl_b32 s5, s9, 8
    s_add_u32 s64, s64, s5
    s_mov_b32 s13, s9
    s_mov_b32 s15, 0
    v_mov_b32 v140, 0
LC_poll:
    ds_read_b32 v20, v136
    s_waitcnt lgkmcnt(0)
    v_readfirstlane_b32 s14, v20
    s_cmp_gt_u32 s14, s13
    s_cbranch_scc1 LC_go
    s_sleep 1
    s_branch LC_poll
LC_go:
    ds_read_b128 v[104:107], v137 offset:0
    ds_read_b128 v[108:111], v137 offset:1024
    ds_read_b128 v[112:115], v137 offset:2048
    ds_read_b128 v[116:119], v137 offset:3072
    ds_read_b128 v[120:123], v137 offset:4096
    ds_read_b128 v[124:127], v137 offset:5120
    ds_read_b128 v[128:131], v137 offset:6144
    ds_read_b128 v[132:135], v137 offset:7168
    s_add_u32 s15, s15, 1
    s_add_u32 s13, s13, 8
    v_add_u32 v140, 1, v140
    v_add_u32 v137, 0x10000, v137
    v_subrev_u32 v21, 147456, v137
    v_min_u32 v137, v21, v137
    s_waitcnt lgkmcnt(4)
    v_dot2_f32_bf16 v24, v104, v4, 0
    v_dot2_f32_bf16 v25, v108, v4, 0
    v_dot2_f32_bf16 v26, v112, v4, 0
    v_dot2_f32_bf16 v27, v116, v4, 0
    v_dot2_f32_bf16 v24, v105, v5, v24
    v_dot2_f32_bf16 v25, v109, v5, v25
    v_dot2_f32_bf16 v26, v113, v5, v26
    v_dot2_f32_bf16 v27, v117, v5, v27
    v_dot2_f32_bf16 v24, v106, v6, v24
    v_dot2_f32_bf16 v25, v110, v6, v25
    v_dot2_f32_bf16 v26, v114, v6, v26
    v_dot2_f32_bf16 v27, v118, v6, v27
    v_dot2_f32_bf16 v24, v107, v7, v24
    v_dot2_f32_bf16 v25, v111, v7, v25
    v_dot2_f32_bf16 v26, v115, v7, v26
    v_dot2_f32_bf16 v27, v119, v7, v27
    s_waitcnt lgkmcnt(0)
    ds_write_b32 v138, v140
    v_add_f32_dpp v24, v24, v24 row_ror:8 row_mask:0xf bank_mask:0x3
    v_add_f32_dpp v24, v26, v26 row_ror:8 row_mask:0xf bank_mask:0xc
    v_add_f32_dpp v25, v25, v25 row_ror:8 row_mask:0xf bank_mask:0x3
    v_add_f32_dpp v25, v27, v27 row_ror:8 row_mask:0xf bank_mask:0xc
    v_perm_b32 v32, v124, v120, s70
    v_perm_b32 v33, v124, v120, s71
    v_perm_b32 v34, v125, v121, s70
    v_perm_b32 v35, v125, v121, s71
    v_add_f32_dpp v24, v24, v24 row_half_mirror row_mask:0xf bank_mask:0x5
    v_add_f32_dpp v24, v25, v25 row_half_mirror row_mask:0xf bank_mask:0xa
    v_perm_b32 v36, v126, v122, s70
    v_perm_b32 v37, v126, v122, s71
    v_perm_b32 v38, v127, v123, s70
    v_perm_b32 v39, v127, v123, s71
    v_add_f32_dpp v24, v24, v24 quad_perm:[1,0,3,2] row_mask:0xf bank_mask:0xf
    v_perm_b32 v104, v132, v128, s70
    v_perm_b32 v105, v132, v128, s71
    v_add_f32_dpp v24, v24, v24 quad_perm:[2,3,0,1] row_mask:0xf bank_mask:0xf
    v_cvt_pk_bf16_f32 v24, v24, v24
    v_and_b32 v24, s42, v24
    v_mul_f32 v24, s68, v24
    v_cvt_pk_bf16_f32 v24, v24, v24
    v_and_b32 v24, s42, v24
    v_perm_b32 v106, v133, v129, s70
    v_perm_b32 v107, v133, v129, s71
    v_max_f32_dpp v25, v24, v24 row_ror:8 row_mask:0xf bank_mask:0xf
    v_perm_b32 v108, v134, v130, s70
    v_perm_b32 v109, v134, v130, s71
    v_max_f32_dpp v25, v25, v25 row_ror:4 row_mask:0xf bank_mask:0xf
    v_perm_b32 v110, v135, v131, s70
    v_perm_b32 v111, v135, v131, s71
    v_max_f32 v25, v25, v17
    v_sub_f32 v26, v17, v25
    v_sub_f32 v16, v24, v25
    v_mul_f32 v26, s69, v26
    v_mul_f32 v16, s69, v16
    v_exp_f32 v26, v26
    v_exp_f32 v16, v16
    v_mov_b32 v17, v25
    v_fma_f32 v18, v18, v26, v16
    v_mul_f32 v8, v26, v8
    v_mov_b32_dpp v27, v16 row_shl:4 row_mask:0xf bank_mask:0xf
    v_mul_f32 v9, v26, v9
    v_cvt_pk_bf16_f32 v16, v16, v27
    v_mul_f32 v10, v26, v10
    v_mul_f32 v11, v26, v11
    v_mul_f32 v12, v26, v12
    v_mul_f32 v13, v26, v13
    v_mul_f32 v14, v26, v14
    v_mul_f32 v15, v26, v15
    v_dot2c_f32_bf16_dpp v8, v16, v32 row_newbcast:0 row_mask:0xf bank_mask:0xf
    v_dot2c_f32_bf16_dpp v9, v16, v33 row_newbcast:0 row_mask:0xf bank_mask:0xf
    v_dot2c_f32_bf16_dpp v10, v16, v34 row_newbcast:0 row_mask:0xf bank_mask:0xf
    v_dot2c_f32_bf16_dpp v11, v16, v35 row_newbcast:0 row_mask:0xf bank_mask:0xf
    v_dot2c_f32_bf16_dpp v12, v16, v36 row_newbcast:0 row_mask:0xf bank_mask:0xf
    v_dot2c_f32_bf16_dpp v13, v16, v37 row_newbcast:0 row_mask:0xf bank_mask:0xf
    v_dot2c_f32_bf16_dpp v14, v16, v38 row_newbcast:0 row_mask:0xf bank_mask:0xf
    v_dot2c_f32_bf16_dpp v15, v16, v39 row_newbcast:0 row_mask:0xf bank_mask:0xf
    v_dot2c_f32_bf16_dpp v8, v16, v104 row_newbcast:8 row_mask:0xf bank_mask:0xf
    v_dot2c_f32_bf16_dpp v9, v16, v105 row_newbcast:8 row_mask:0xf bank_mask:0xf
    v_dot2c_f32_bf16_dpp v10, v16, v106 row_newbcast:8 row_mask:0xf bank_mask:0xf
    v_dot2c_f32_bf16_dpp v11, v16, v107 row_newbcast:8 row_mask:0xf bank_mask:0xf
    v_dot2c_f32_bf16_dpp v12, v16, v108 row_newbcast:8 row_mask:0xf bank_mask:0xf
    v_dot2c_f32_bf16_dpp v13, v16, v109 row_newbcast:8 row_mask:0xf bank_mask:0xf
    v_dot2c_f32_bf16_dpp v14, v16, v110 row_newbcast:8 row_mask:0xf bank_mask:0xf
    v_dot2c_f32_bf16_dpp v15, v16, v111 row_newbcast:8 row_mask:0xf bank_mask:0xf
    v_mfma_f32_16x16x32_bf16 v[164:167], v[4:7], v[4:7], 0
    s_cmp_le_u32 s15, 8
    s_cbranch_scc1 LC_wo
    s_cmp_eq_u32 s15, 11
    s_cbranch_scc1 LC_prep
    s_cmp_lt_u32 s13, s79
    s_cbranch_scc1 LC_poll
    s_branch LA_tail
LC_wo:
    s_cmp_lg_u32 s15, 1
    s_cbranch_scc1 LC_wo1
    s_add_u32 s4, s43, 0
    buffer_load_dwordx2 v[40:41], v142, s[52:55], s4 offen offset:0
    buffer_load_dwordx2 v[42:43], v142, s[52:55], s4 offen offset:1024
    buffer_load_dwordx2 v[44:45], v142, s[52:55], s4 offen offset:2048
    buffer_load_dwordx2 v[46:47], v142, s[52:55], s4 offen offset:3072
    s_branch LC_poll
LC_wo1:
    s_cmp_lg_u32 s15, 2
    s_cbranch_scc1 LC_wo2
    s_add_u32 s4, s43, 4096
    buffer_load_dwordx2 v[48:49], v142, s[52:55], s4 offen offset:0
    buffer_load_dwordx2 v[50:51], v142, s[52:55], s4 offen offset:1024
    buffer_load_dwordx2 v[52:53], v142, s[52:55], s4 offen offset:2048
    buffer_load_dwordx2 v[54:55], v142, s[52:55], s4 offen offset:3072
    s_branch LC_poll
LC_wo2:
    s_cmp_lg_u32 s15, 3
    s_cbranch_scc1 LC_wo3
    s_add_u32 s4, s43, 8192
    buffer_load_dwordx2 v[56:57], v142, s[52:55], s4 offen offset:0
    buffer_load_dwordx2 v[58:59], v142, s[52:55], s4 offen offset:1024
    buffer_load_dwordx2 v[60:61], v142, s[52:55], s4 offen offset:2048
    buffer_load_dwordx2 v[62:63], v142, s[52:55], s4 offen offset:3072
    s_branch LC_poll
LC_wo3:
    s_cmp_lg_u32 s15, 4
    s_cbranch_scc1 LC_wo4
    s_add_u32 s4, s43, 12288
    buffer_load_dwordx2 v[64:65], v142, s[52:55], s4 offen offset:0
    buffer_load_dwordx2 v[66:67], v142, s[52:55], s4 offen offset:1024
    buffer_load_dwordx2 v[68:69], v142, s[52:55], s4 offen offset:2048
    buffer_load_dwordx2 v[70:71], v142, s[52:55], s4 offen offset:3072
    s_branch LC_poll
LC_wo4:
    s_cmp_lg_u32 s15, 5
    s_cbranch_scc1 LC_wo5
    s_add_u32 s4, s43, 16384
    buffer_load_dwordx2 v[72:73], v142, s[52:55], s4 offen offset:0
    buffer_load_dwordx2 v[74:75], v142, s[52:55], s4 offen offset:1024
    buffer_load_dwordx2 v[76:77], v142, s[52:55], s4 offen offset:2048
    buffer_load_dwordx2 v[78:79], v142, s[52:55], s4 offen offset:3072
    s_branch LC_poll
LC_wo5:
    s_cmp_lg_u32 s15, 6
    s_cbranch_scc1 LC_wo6
    s_add_u32 s4, s43, 20480
    buffer_load_dwordx2 v[80:81], v142, s[52:55], s4 offen offset:0
    buffer_load_dwordx2 v[82:83], v142, s[52:55], s4 offen offset:1024
    buffer_load_dwordx2 v[84:85], v142, s[52:55], s4 offen offset:2048
    buffer_load_dwordx2 v[86:87], v142, s[52:55], s4 offen offset:3072
    s_branch LC_poll
LC_wo6:
    s_cmp_lg_u32 s15, 7
    s_cbranch_scc1 LC_wo7
    s_add_u32 s4, s43, 24576
    buffer_load_dwordx2 v[88:89], v142, s[52:55], s4 offen offset:0
    buffer_load_dwordx2 v[90:91], v142, s[52:55], s4 offen offset:1024
    buffer_load_dwordx2 v[92:93], v142, s[52:55], s4 offen offset:2048
    buffer_load_dwordx2 v[94:95], v142, s[52:55], s4 offen offset:3072
    s_branch LC_poll
LC_wo7:
    s_cmp_lg_u32 s15, 8
    s_cbranch_scc1 LC_poll
    s_add_u32 s4, s43, 28672
    buffer_load_dwordx2 v[96:97], v142, s[52:55], s4 offen offset:0
    buffer_load_dwordx2 v[98:99], v142, s[52:55], s4 offen offset:1024
    buffer_load_dwordx2 v[100:101], v142, s[52:55], s4 offen offset:2048
    buffer_load_dwordx2 v[102:103], v142, s[52:55], s4 offen offset:3072
    s_branch LC_poll
LC_prep:
    s_waitcnt vmcnt(0)
    v_perm_b32 v148, v42, v40, s70
    v_perm_b32 v152, v42, v40, s71
    v_perm_b32 v156, v43, v41, s70
    v_perm_b32 v160, v43, v41, s71
    v_perm_b32 v149, v46, v44, s70
    v_perm_b32 v153, v46, v44, s71
    v_perm_b32 v157, v47, v45, s70
    v_perm_b32 v161, v47, v45, s71
    v_perm_b32 v150, v50, v48, s70
    v_perm_b32 v154, v50, v48, s71
    v_perm_b32 v158, v51, v49, s70
    v_perm_b32 v162, v51, v49, s71
    v_perm_b32 v151, v54, v52, s70
    v_perm_b32 v155, v54, v52, s71
    v_perm_b32 v159, v55, v53, s70
    v_perm_b32 v163, v55, v53, s71
    v_perm_b32 v40, v58, v56, s70
    v_perm_b32 v44, v58, v56, s71
    v_perm_b32 v48, v59, v57, s70
    v_perm_b32 v52, v59, v57, s71
    v_perm_b32 v41, v62, v60, s70
    v_perm_b32 v45, v62, v60, s71
    v_perm_b32 v49, v63, v61, s70
    v_perm_b32 v53, v63, v61, s71
    v_perm_b32 v42, v66, v64, s70
    v_perm_b32 v46, v66, v64, s71
    v_perm_b32 v50, v67, v65, s70
    v_perm_b32 v54, v67, v65, s71
    v_perm_b32 v43, v70, v68, s70
    v_perm_b32 v47, v70, v68, s71
    v_perm_b32 v51, v71, v69, s70
    v_perm_b32 v55, v71, v69, s71
    v_perm_b32 v56, v74, v72, s70
    v_perm_b32 v60, v74, v72, s71
    v_perm_b32 v64, v75, v73, s70
    v_perm_b32 v68, v75, v73, s71
    v_perm_b32 v57, v78, v76, s70
    v_perm_b32 v61, v78, v76, s71
    v_perm_b32 v65, v79, v77, s70
    v_perm_b32 v69, v79, v77, s71
    v_perm_b32 v58, v82, v80, s70
    v_perm_b32 v62, v82, v80, s71
    v_perm_b32 v66, v83, v81, s70
    v_perm_b32 v70, v83, v81, s71
    v_perm_b32 v59, v86, v84, s70
    v_perm_b32 v63, v86, v84, s71
    v_perm_b32 v67, v87, v85, s70
    v_perm_b32 v71, v87, v85, s71
    v_perm_b32 v72, v90, v88, s70
    v_perm_b32 v76, v90, v88, s71
    v_perm_b32 v80, v91, v89, s70
    v_perm_b32 v84, v91, v89, s71
    v_perm_b32 v73, v94, v92, s70
    v_perm_b32 v77, v94, v92, s71
    v_perm_b32 v81, v95, v93, s70
    v_perm_b32 v85, v95, v93, s71
    v_perm_b32 v74, v98, v96, s70
    v_perm_b32 v78, v98, v96, s71
    v_perm_b32 v82, v99, v97, s70
    v_perm_b32 v86, v99, v97, s71
    v_perm_b32 v75, v102, v100, s70
    v_perm_b32 v79, v102, v100, s71
    v_perm_b32 v83, v103, v101, s70
    v_perm_b32 v87, v103, v101, s71
    s_branch LC_poll
LA_tail:
    s_nop 2
    v_add_f32_dpp v18, v18, v18 row_ror:8 row_mask:0xf bank_mask:0xf
    s_nop 1
    v_add_f32_dpp v18, v18, v18 row_ror:4 row_mask:0xf bank_mask:0xf
    v_readlane_b32 s80, v17, 0
    v_readlane_b32 s81, v17, 16
    v_readlane_b32 s82, v17, 32
    v_readlane_b32 s83, v17, 48
    v_mov_b32 v20, s80
    v_max_f32 v20, s81, v20
    v_max_f32 v20, s82, v20
    v_max_f32 v20, s83, v20
    v_sub_f32 v22, v17, v20
    v_mul_f32 v22, s69, v22
    v_exp_f32 v22, v22
    s_nop 0
    v_mul_f32 v18, v22, v18
    v_mul_f32 v8, v22, v8
    v_mul_f32 v9, v22, v9
    v_mul_f32 v10, v22, v10
    v_mul_f32 v11, v22, v11
    v_mul_f32 v12, v22, v12
    v_mul_f32 v13, v22, v13
    v_mul_f32 v14, v22, v14
    v_mul_f32 v15, v22, v15
    v_readlane_b32 s80, v18, 0
    v_readlane_b32 s81, v18, 16
    v_readlane_b32 s82, v18, 32
    v_readlane_b32 s83, v18, 48
    v_permlane32_swap_b32 v8, v9
    v_permlane32_swap_b32 v10, v11
    v_permlane32_swap_b32 v12, v13
    v_permlane32_swap_b32 v14, v15
    v_add_f32 v8, v8, v9
    v_add_f32 v10, v10, v11
    v_add_f32 v12, v12, v13
    v_add_f32 v14, v14, v15
    v_permlane16_swap_b32 v8, v10
    s_nop 0
    v_permlane16_swap_b32 v12, v14
    v_add_f32 v8, v8, v10
    v_add_f32 v12, v12, v14
    v_mov_b32 v21, s80
    v_add_f32 v21, s81, v21
    v_add_f32 v21, s82, v21
    v_add_f32 v21, s83, v21
    ds_write_b32 v19, v8 offset:0
    ds_write_b32 v19, v12 offset:16
    s_lshl_b32 s4, s9, 3
    s_add_u32 s4, s4, 151808
    v_mov_b32 v22, s4
    ds_write_b64 v22, v[20:21]
    v_lshlrev_b32 v20, 3, v0
    v_add_u32 v20, 147712, v20
    v_and_b32 v21, 7, v0
    v_lshlrev_b32 v21, 3, v21
    v_add_u32 v21, 151808, v21
    s_waitcnt lgkmcnt(0)
    s_mov_b64 exec, 1
    ds_add_u32 v136, v139 offset:68
    s_mov_b64 exec, -1
LB_spint1:
    ds_read_b32 v23, v136 offset:68
    s_waitcnt lgkmcnt(0)
    v_readfirstlane_b32 s14, v23
    s_cmp_lt_u32 s14, 9
    s_cbranch_scc1 LB_spint1
    ds_read_b64 v[104:105], v21
    ds_read_b64 v[24:25], v20 offset:0
    ds_read_b64 v[26:27], v20 offset:512
    ds_read_b64 v[28:29], v20 offset:1024
    ds_read_b64 v[30:31], v20 offset:1536
    ds_read_b64 v[32:33], v20 offset:2048
    ds_read_b64 v[34:35], v20 offset:2560
    ds_read_b64 v[36:37], v20 offset:3072
    ds_read_b64 v[38:39], v20 offset:3584
    v_mfma_f32_16x16x32_bf16 v[164:167], v[4:7], v[4:7], 0
    s_lshl_b32 s4, s9, 3
    s_mov_b32 s80, 0x7060500
    s_mov_b32 s81, 0x7060501
    s_mov_b32 s82, 0x7060502
    s_mov_b32 s83, 0x7060503
    s_waitcnt lgkmcnt(8)
    v_max_f32_dpp v20, v104, v104 row_ror:4 row_mask:0xf bank_mask:0xf
    s_nop 1
    v_max_f32_dpp v20, v20, v20 row_ror:2 row_mask:0xf bank_mask:0xf
    s_nop 1
    v_max_f32_dpp v20, v20, v20 row_ror:1 row_mask:0xf bank_mask:0xf
    v_sub_f32 v104, v104, v20
    v_mul_f32 v104, s69, v104
    v_exp_f32 v104, v104
    s_nop 0
    v_mul_f32 v21, v104, v105
    s_nop 1
    v_add_f32_dpp v21, v21, v21 row_ror:4 row_mask:0xf bank_mask:0xf
    s_nop 1
    v_add_f32_dpp v21, v21, v21 row_ror:2 row_mask:0xf bank_mask:0xf
    s_nop 1
    v_add_f32_dpp v21, v21, v21 row_ror:1 row_mask:0xf bank_mask:0xf
    v_rcp_f32 v22, v21
    v_log_f32 v21, v21
    v_mul_f32 v104, v104, v22
    v_fmac_f32 v21, s69, v20
    s_waitcnt lgkmcnt(0)
    v_mul_f32_dpp v2, v104, v24 row_newbcast:0 row_mask:0xf bank_mask:0xf
    v_mul_f32_dpp v3, v104, v25 row_newbcast:0 row_mask:0xf bank_mask:0xf
    v_fmac_f32_dpp v2, v104, v26 row_newbcast:1 row_mask:0xf bank_mask:0xf
    v_fmac_f32_dpp v3, v104, v27 row_newbcast:1 row_mask:0xf bank_mask:0xf
    v_fmac_f32_dpp v2, v104, v28 row_newbcast:2 row_mask:0xf bank_mask:0xf
    v_fmac_f32_dpp v3, v104, v29 row_newbcast:2 row_mask:0xf bank_mask:0xf
    v_fmac_f32_dpp v2, v104, v30 row_newbcast:3 row_mask:0xf bank_mask:0xf
    v_fmac_f32_dpp v3, v104, v31 row_newbcast:3 row_mask:0xf bank_mask:0xf
    v_fmac_f32_dpp v2, v104, v32 row_newbcast:4 row_mask:0xf bank_mask:0xf
    v_fmac_f32_dpp v3, v104, v33 row_newbcast:4 row_mask:0xf bank_mask:0xf
    v_fmac_f32_dpp v2, v104, v34 row_newbcast:5 row_mask:0xf bank_mask:0xf
    v_fmac_f32_dpp v3, v104, v35 row_newbcast:5 row_mask:0xf bank_mask:0xf
    v_fmac_f32_dpp v2, v104, v36 row_newbcast:6 row_mask:0xf bank_mask:0xf
    v_fmac_f32_dpp v3, v104, v37 row_newbcast:6 row_mask:0xf bank_mask:0xf
    v_fmac_f32_dpp v2, v104, v38 row_newbcast:7 row_mask:0xf bank_mask:0xf
    v_fmac_f32_dpp v3, v104, v39 row_newbcast:7 row_mask:0xf bank_mask:0xf
    v_cvt_pk_bf16_f32 v2, v2, v3
    s_nop 1
    v_mov_b32_dpp v108, v2 row_newbcast:0 row_mask:0xf bank_mask:0xf
    v_mov_b32_dpp v109, v2 row_newbcast:1 row_mask:0xf bank_mask:0xf
    v_mov_b32_dpp v110, v2 row_newbcast:2 row_mask:0xf bank_mask:0xf
    v_mov_b32_dpp v111, v2 row_newbcast:3 row_mask:0xf bank_mask:0xf
    s_nop 1
    v_mfma_f32_16x16x32_bf16 v[24:27], v[108:111], v[148:151], 0
    v_mov_b32_dpp v112, v2 row_newbcast:4 row_mask:0xf bank_mask:0xf
    v_mov_b32_dpp v113, v2 row_newbcast:5 row_mask:0xf bank_mask:0xf
    v_mfma_f32_16x16x32_bf16 v[28:31], v[108:111], v[152:155], 0
    v_mov_b32_dpp v114, v2 row_newbcast:6 row_mask:0xf bank_mask:0xf
    v_mov_b32_dpp v115, v2 row_newbcast:7 row_mask:0xf bank_mask:0xf
    v_mfma_f32_16x16x32_bf16 v[32:35], v[108:111], v[156:159], 0
    v_mfma_f32_16x16x32_bf16 v[36:39], v[108:111], v[160:163], 0
    v_mfma_f32_16x16x32_bf16 v[24:27], v[112:115], v[40:43], v[24:27]
    v_mov_b32_dpp v116, v2 row_newbcast:8 row_mask:0xf bank_mask:0xf
    v_mov_b32_dpp v117, v2 row_newbcast:9 row_mask:0xf bank_mask:0xf
    v_mfma_f32_16x16x32_bf16 v[28:31], v[112:115], v[44:47], v[28:31]
    v_mov_b32_dpp v118, v2 row_newbcast:10 row_mask:0xf bank_mask:0xf
    v_mov_b32_dpp v119, v2 row_newbcast:11 row_mask:0xf bank_mask:0xf
    v_mfma_f32_16x16x32_bf16 v[32:35], v[112:115], v[48:51], v[32:35]
    v_mfma_f32_16x16x32_bf16 v[36:39], v[112:115], v[52:55], v[36:39]
    v_mfma_f32_16x16x32_bf16 v[24:27], v[116:119], v[56:59], v[24:27]
    v_mov_b32_dpp v120, v2 row_newbcast:12 row_mask:0xf bank_mask:0xf
    v_mov_b32_dpp v121, v2 row_newbcast:13 row_mask:0xf bank_mask:0xf
    v_mfma_f32_16x16x32_bf16 v[28:31], v[116:119], v[60:63], v[28:31]
    v_mov_b32_dpp v122, v2 row_newbcast:14 row_mask:0xf bank_mask:0xf
    v_mov_b32_dpp v123, v2 row_newbcast:15 row_mask:0xf bank_mask:0xf
    v_mfma_f32_16x16x32_bf16 v[32:35], v[116:119], v[64:67], v[32:35]
    v_mfma_f32_16x16x32_bf16 v[36:39], v[116:119], v[68:71], v[36:39]
    v_mfma_f32_16x16x32_bf16 v[24:27], v[120:123], v[72:75], v[24:27]
    v_mfma_f32_16x16x32_bf16 v[28:31], v[120:123], v[76:79], v[28:31]
    v_mfma_f32_16x16x32_bf16 v[32:35], v[120:123], v[80:83], v[32:35]
    v_mfma_f32_16x16x32_bf16 v[36:39], v[120:123], v[84:87], v[36:39]
    s_mov_b64 exec, 0xffff
    s_nop 3
    v_perm_b32 v8, v24, v21, s80
    v_perm_b32 v9, v28, v21, s81
    v_perm_b32 v10, v32, v21, s82
    v_perm_b32 v11, v36, v21, s83
    buffer_store_dwordx4 v[8:11], v1, s[60:63], s64 offen sc1
    s_mov_b64 exec, -1
LA_end2:
    s_endpgm
LA_mon:
    s_memrealtime s[66:67]
    s_and_b32 s15, s2, 7
    s_mul_i32 s4, s15, 4352
    s_add_u32 s4, s4, 2097152
    s_add_u32 s60, s40, s4
    s_addc_u32 s61, s41, 0
    s_movk_i32 s62, 128
    s_lshr_b32 s12, s2, 3
    s_lshl_b32 s12, s12, 2
    v_lshlrev_b32 v5, 2, v0
    v_mov_b32 v7, 0
    v_mov_b32 v6, 147456
    s_sub_u32 s10, s79, 128
    s_sub_u32 s11, s79, 6
    s_mov_b64 exec, 1
    s_waitcnt lgkmcnt(0)
    s_mul_i32 s4, s66, 33
    s_sub_u32 s4, 0, s4
    v_mov_b32 v4, s4
    buffer_store_dword v4, v7, s[60:63], s12 offen
    s_mov_b32 s56, s40
    s_mov_b32 s57, s41
    s_mov_b32 s58, 1157888
    s_mov_b32 s52, s38
    s_mov_b32 s53, s39
    s_movk_i32 s54, 256
    s_lshl_b32 s4, s7, 6
    s_lshl_b32 s5, s6, 1
    s_add_u32 s4, s4, s5
    s_add_u32 s4, s4, s8
    s_lshl_b32 s5, s4, 3
    s_add_u32 s5, s5, 524288
    s_lshl_b32 s4, s4, 11
    s_mov_b64 exec, -1
    v_mov_b32 v8, -1
    v_mov_b32 v9, -1
    v_mov_b32 v10, -1
    v_mov_b32 v11, -1
    buffer_store_dwordx4 v[8:11], v1, s[56:59], s4 offen sc1
    buffer_store_dwordx4 v[8:11], v1, s[56:59], s4 offen offset:1024 sc1
    s_cmp_lg_u32 s75, 3
    s_cbranch_scc1 LM_pz1
    v_lshrrev_b32 v12, 4, v0
    v_lshlrev_b32 v12, 11, v12
    v_and_b32 v13, 7, v0
    v_lshl_add_u32 v12, v13, 5, v12
    v_bfe_u32 v13, v0, 3, 1
    v_lshl_add_u32 v12, v13, 4, v12
    s_lshl_b32 s4, s76, 13
    s_lshl_b32 s5, s77, 8
    s_add_u32 s4, s4, s5
    s_add_u32 s4, s4, 1048576
    buffer_store_dwordx4 v[8:11], v12, s[56:59], s4 offen sc1
    s_branch LM_pz2
LM_pz1:
    s_lshl_b32 s4, s7, 5
    s_add_u32 s4, s4, s6
    s_cmp_ge_u32 s4, 86
    s_cbranch_scc1 LM_pz2
    s_cmp_lg_u32 s8, 0
    s_cbranch_scc1 LM_pz2
    v_lshrrev_b32 v12, 4, v0
    v_mul_u32_u24 v12, 2752, v12
    v_and_b32 v13, 1, v0
    v_lshl_add_u32 v12, v13, 4, v12
    s_lshl_b32 s4, s4, 5
    s_add_u32 s4, s4, 1146880
    s_mov_b32 s64, 0x00030003
    s_mov_b32 s65, 0x00030003
    s_mov_b64 exec, s[64:65]
    buffer_store_dwordx4 v[8:11], v12, s[56:59], s4 offen sc1
LM_pz2:
    s_mov_b64 exec, 1
    v_mov_b32 v12, 1
    s_lshl_b32 s4, s15, 5
    s_waitcnt vmcnt(0)
    ds_add_u32 v6, v12 offset:68
    ds_write_b32 v6, v12 offset:72
    buffer_atomic_add v12, v7, s[52:55], s4 offen offset:8
LM_loop:
    s_sleep 16
    ds_read_b32 v4, v6
    s_memrealtime s[66:67]
    s_waitcnt lgkmcnt(0)
    v_readfirstlane_b32 s14, v4
    s_cmp_ge_u32 s14, s11
    s_cbranch_scc1 LM_last
    s_sub_u32 s4, s14, s10
    s_lshl_b32 s4, s4, 10
    s_mul_i32 s5, s66, 33
    s_sub_u32 s13, s4, s5
    v_mov_b32 v4, s13
    buffer_store_dword v4, v7, s[60:63], s12 offen
    s_cmp_lt_u32 s14, 8
    s_cbranch_scc1 LM_loop
    s_mov_b64 exec, -1
    buffer_load_dword v8, v5, s[60:63], 0 offen sc1
    s_lshl_b32 s13, s13, 5
    s_waitcnt vmcnt(0)
    v_add_u32_dpp v8, v8, v8 row_ror:1 row_mask:0xf bank_mask:0xf
    s_nop 1
    v_add_u32_dpp v8, v8, v8 row_ror:2 row_mask:0xf bank_mask:0xf
    s_nop 1
    v_add_u32_dpp v8, v8, v8 row_ror:4 row_mask:0xf bank_mask:0xf
    s_nop 1
    v_add_u32_dpp v8, v8, v8 row_ror:8 row_mask:0xf bank_mask:0xf
    s_nop 0
    v_readlane_b32 s4, v8, 0
    v_readlane_b32 s5, v8, 16
    s_mov_b64 exec, 1
    s_add_u32 s4, s4, s5
    s_sub_u32 s13, s4, s13
    s_mov_b32 s5, 0
    s_cmp_gt_i32 s13, 32768
    s_cselect_b32 s5, 1, s5
    s_cmp_gt_i32 s13, 98304
    s_cselect_b32 s5, 2, s5
    v_mov_b32 v4, s5
    ds_write_b32 v6, v4 offset:128
    s_branch LM_loop
LM_last:
    s_endpgm
LA_ffn:
    s_cmp_eq_u32 s75, 2
    s_cbranch_scc1 LA_red
    s_cmp_eq_u32 s75, 3
    s_cbranch_scc1 LA_st2
    s_mov_b32 s6, s5
    s_cmp_ge_u32 s6, 86
    s_cbranch_scc1 LA_end
    s_cmp_lg_u32 s8, 0
    s_cbranch_scc1 LA_end
    v_mov_b32 v4, 147460
LF_wait:
    s_sleep 8
    ds_read_b32 v5, v4
    s_waitcnt lgkmcnt(0)
    v_readfirstlane_b32 s4, v5
    s_cmp_lt_u32 s4, 1
    s_cbranch_scc1 LF_wait
    v_lshrrev_b32 v20, 1, v0
    v_and_b32 v21, 1, v0
    s_movk_i32 s4, 2752
    v_mul_lo_u32 v2, v20, s4
    v_lshl_add_u32 v2, v21, 4, v2
    v_lshlrev_b32 v3, 4, v20
    v_add_u32 v3, 154112, v3
    s_mov_b32 s46, 1409024
    s_mov_b32 s50, 1409024
    s_mov_b32 s58, 4096
    s_mov_b32 s62, 704512
    s_lshl_b32 s10, s6, 5
    s_mov_b32 s44, s28
    s_mov_b32 s45, s29
    s_mov_b32 s48, s30
    s_mov_b32 s49, s31
    s_mov_b32 s56, s16
    s_mov_b32 s57, s17
    s_add_u32 s60, s40, 1048576
    s_addc_u32 s61, s41, 0
    buffer_load_dwordx4 v[4:7], v1, s[56:59], 0 offen offset:0
    buffer_load_dwordx4 v[8:11], v1, s[56:59], 0 offen offset:1024
    buffer_load_dwordx4 v[12:15], v1, s[56:59], 0 offen offset:2048
    buffer_load_dwordx4 v[16:19], v1, s[56:59], 0 offen offset:3072
    s_mov_b32 s11, s10
    buffer_load_dwordx4 v[104:107], v2, s[44:47], s11 offen
    s_add_u32 s11, s11, 88064
    buffer_load_dwordx4 v[108:111], v2, s[44:47], s11 offen
    s_add_u32 s11, s11, 88064
    s_waitcnt vmcnt(2)
    v_lshlrev_b32 v40, 16, v4
    v_lshlrev_b32 v41, 16, v8
    v_lshlrev_b32 v42, 16, v12
    v_lshlrev_b32 v43, 16, v16
    v_and_b32 v44, s42, v4
    v_and_b32 v45, s42, v8
    v_and_b32 v46, s42, v12
    v_and_b32 v47, s42, v16
    v_lshlrev_b32 v48, 16, v5
    v_lshlrev_b32 v49, 16, v9
    v_lshlrev_b32 v50, 16, v13
    v_lshlrev_b32 v51, 16, v17
    v_and_b32 v52, s42, v5
    v_and_b32 v53, s42, v9
    v_and_b32 v54, s42, v13
    v_and_b32 v55, s42, v17
    v_lshlrev_b32 v56, 16, v6
    v_lshlrev_b32 v57, 16, v10
    v_lshlrev_b32 v58, 16, v14
    v_lshlrev_b32 v59, 16, v18
    v_and_b32 v60, s42, v6
    v_and_b32 v61, s42, v10
    v_and_b32 v62, s42, v14
    v_and_b32 v63, s42, v18
    v_lshlrev_b32 v64, 16, v7
    v_lshlrev_b32 v65, 16, v11
    v_lshlrev_b32 v66, 16, v15
    v_lshlrev_b32 v67, 16, v19
    v_and_b32 v68, s42, v7
    v_and_b32 v69, s42, v11
    v_and_b32 v70, s42, v15
    v_and_b32 v71, s42, v19
    v_lshlrev_b32 v20, 7, v0
    v_add_u32 v20, 154112, v20
    ds_write_b128 v20, v[40:43] offset:0
    ds_write_b128 v20, v[44:47] offset:16
    ds_write_b128 v20, v[48:51] offset:32
    ds_write_b128 v20, v[52:55] offset:48
    ds_write_b128 v20, v[56:59] offset:64
    ds_write_b128 v20, v[60:63] offset:80
    ds_write_b128 v20, v[64:67] offset:96
    ds_write_b128 v20, v[68:71] offset:112
    s_waitcnt lgkmcnt(0)
    s_mov_b32 s9, 0
    v_mov_b32 v22, v2
    s_mov_b32 s12, 88064
LF_pass:
    v_mov_b32 v40, 0
    v_mov_b32 v41, 0
    v_mov_b32 v42, 0
    v_mov_b32 v43, 0
    v_mov_b32 v44, 0
    v_mov_b32 v45, 0
    v_mov_b32 v46, 0
    v_mov_b32 v47, 0
    v_mov_b32 v48, 0
    v_mov_b32 v49, 0
    v_mov_b32 v50, 0
    v_mov_b32 v51, 0
    v_mov_b32 v52, 0
    v_mov_b32 v53, 0
    v_mov_b32 v54, 0
    v_mov_b32 v55, 0
    v_mov_b32 v56, 0
    v_mov_b32 v57, 0
    v_mov_b32 v58, 0
    v_mov_b32 v59, 0
    v_mov_b32 v60, 0
    v_mov_b32 v61, 0
    v_mov_b32 v62, 0
    v_mov_b32 v63, 0
    v_mov_b32 v64, 0
    v_mov_b32 v65, 0
    v_mov_b32 v66, 0
    v_mov_b32 v67, 0
    v_mov_b32 v68, 0
    v_mov_b32 v69, 0
    v_mov_b32 v70, 0
    v_mov_b32 v71, 0
    ds_read_b128 v[72:75], v3
    ds_read_b128 v[76:79], v3 offset:512
    s_waitcnt vmcnt(1)
    v_lshlrev_b32 v80, 16, v104
    v_and_b32 v81, s42, v104
    v_lshlrev_b32 v82, 16, v105
    v_and_b32 v83, s42, v105
    v_lshlrev_b32 v84, 16, v106
    v_and_b32 v85, s42, v106
    v_lshlrev_b32 v86, 16, v107
    v_and_b32 v87, s42, v107
    buffer_load_dwordx4 v[112:115], v2, s[44:47], s11 offen
    s_add_u32 s11, s11, 88064
    s_waitcnt lgkmcnt(1)
    v_fmac_f32 v40, v72, v80
    v_fmac_f32 v41, v72, v81
    v_fmac_f32 v42, v72, v82
    v_fmac_f32 v43, v72, v83
    v_fmac_f32 v44, v72, v84
    v_fmac_f32 v45, v72, v85
    v_fmac_f32 v46, v72, v86
    v_fmac_f32 v47, v72, v87
    v_fmac_f32 v48, v73, v80
    v_fmac_f32 v49, v73, v81
    v_fmac_f32 v50, v73, v82
    v_fmac_f32 v51, v73, v83
    v_fmac_f32 v52, v73, v84
    v_fmac_f32 v53, v73, v85
    v_fmac_f32 v54, v73, v86
    v_fmac_f32 v55, v73, v87
    v_fmac_f32 v56, v74, v80
    v_fmac_f32 v57, v74, v81
    v_fmac_f32 v58, v74, v82
    v_fmac_f32 v59, v74, v83
    v_fmac_f32 v60, v74, v84
    v_fmac_f32 v61, v74, v85
    v_fmac_f32 v62, v74, v86
    v_fmac_f32 v63, v74, v87
    v_fmac_f32 v64, v75, v80
    v_fmac_f32 v65, v75, v81
    v_fmac_f32 v66, v75, v82
    v_fmac_f32 v67, v75, v83
    v_fmac_f32 v68, v75, v84
    v_fmac_f32 v69, v75, v85
    v_fmac_f32 v70, v75, v86
    v_fmac_f32 v71, v75, v87
    ds_read_b128 v[72:75], v3 offset:1024
    s_waitcnt vmcnt(1)
    v_lshlrev_b32 v80, 16, v108
    v_and_b32 v81, s42, v108
    v_lshlrev_b32 v82, 16, v109
    v_and_b32 v83, s42, v109
    v_lshlrev_b32 v84, 16, v110
    v_and_b32 v85, s42, v110
    v_lshlrev_b32 v86, 16, v111
    v_and_b32 v87, s42, v111
    buffer_load_dwordx4 v[116:119], v2, s[44:47], s11 offen
    s_add_u32 s11, s11, 88064
    s_waitcnt lgkmcnt(1)
    v_fmac_f32 v40, v76, v80
    v_fmac_f32 v41, v76, v81
    v_fmac_f32 v42, v76, v82
    v_fmac_f32 v43, v76, v83
    v_fmac_f32 v44, v76, v84
    v_fmac_f32 v45, v76, v85
    v_fmac_f32 v46, v76, v86
    v_fmac_f32 v47, v76, v87
    v_fmac_f32 v48, v77, v80
    v_fmac_f32 v49, v77, v81
    v_fmac_f32 v50, v77, v82
    v_fmac_f32 v51, v77, v83
    v_fmac_f32 v52, v77, v84
    v_fmac_f32 v53, v77, v85
    v_fmac_f32 v54, v77, v86
    v_fmac_f32 v55, v77, v87
    v_fmac_f32 v56, v78, v80
    v_fmac_f32 v57, v78, v81
    v_fmac_f32 v58, v78, v82
    v_fmac_f32 v59, v78, v83
    v_fmac_f32 v60, v78, v84
    v_fmac_f32 v61, v78, v85
    v_fmac_f32 v62, v78, v86
    v_fmac_f32 v63, v78, v87
    v_fmac_f32 v64, v79, v80
    v_fmac_f32 v65, v79, v81
    v_fmac_f32 v66, v79, v82
    v_fmac_f32 v67, v79, v83
    v_fmac_f32 v68, v79, v84
    v_fmac_f32 v69, v79, v85
    v_fmac_f32 v70, v79, v86
    v_fmac_f32 v71, v79, v87
    ds_read_b128 v[76:79], v3 offset:1536
    s_waitcnt vmcnt(1)
    v_lshlrev_b32 v80, 16, v112
    v_and_b32 v81, s42, v112
    v_lshlrev_b32 v82, 16, v113
    v_and_b32 v83, s42, v113
    v_lshlrev_b32 v84, 16, v114
    v_and_b32 v85, s42, v114
    v_lshlrev_b32 v86, 16, v115
    v_and_b32 v87, s42, v115
    buffer_load_dwordx4 v[120:123], v2, s[44:47], s11 offen
    s_add_u32 s11, s11, 88064
    s_waitcnt lgkmcnt(1)
    v_fmac_f32 v40, v72, v80
    v_fmac_f32 v41, v72, v81
    v_fmac_f32 v42, v72, v82
    v_fmac_f32 v43, v72, v83
    v_fmac_f32 v44, v72, v84
    v_fmac_f32 v45, v72, v85
    v_fmac_f32 v46, v72, v86
    v_fmac_f32 v47, v72, v87
    v_fmac_f32 v48, v73, v80
    v_fmac_f32 v49, v73, v81
    v_fmac_f32 v50, v73, v82
    v_fmac_f32 v51, v73, v83
    v_fmac_f32 v52, v73, v84
    v_fmac_f32 v53, v73, v85
    v_fmac_f32 v54, v73, v86
    v_fmac_f32 v55, v73, v87
    v_fmac_f32 v56, v74, v80
    v_fmac_f32 v57, v74, v81
    v_fmac_f32 v58, v74, v82
    v_fmac_f32 v59, v74, v83
    v_fmac_f32 v60, v74, v84
    v_fmac_f32 v61, v74, v85
    v_fmac_f32 v62, v74, v86
    v_fmac_f32 v63, v74, v87
    v_fmac_f32 v64, v75, v80
    v_fmac_f32 v65, v75, v81
    v_fmac_f32 v66, v75, v82
    v_fmac_f32 v67, v75, v83
    v_fmac_f32 v68, v75, v84
    v_fmac_f32 v69, v75, v85
    v_fmac_f32 v70, v75, v86
    v_fmac_f32 v71, v75, v87
    ds_read_b128 v[72:75], v3 offset:2048
    s_waitcnt vmcnt(1)
    v_lshlrev_b32 v80, 16, v116
    v_and_b32 v81, s42, v116
    v_lshlrev_b32 v82, 16, v117
    v_and_b32 v83, s42, v117
    v_lshlrev_b32 v84, 16, v118
    v_and_b32 v85, s42, v118
    v_lshlrev_b32 v86, 16, v119
    v_and_b32 v87, s42, v119
    buffer_load_dwordx4 v[124:127], v2, s[44:47], s11 offen
    s_add_u32 s11, s11, 88064
    s_waitcnt lgkmcnt(1)
    v_fmac_f32 v40, v76, v80
    v_fmac_f32 v41, v76, v81
    v_fmac_f32 v42, v76, v82
    v_fmac_f32 v43, v76, v83
    v_fmac_f32 v44, v76, v84
    v_fmac_f32 v45, v76, v85
    v_fmac_f32 v46, v76, v86
    v_fmac_f32 v47, v76, v87
    v_fmac_f32 v48, v77, v80
    v_fmac_f32 v49, v77, v81
    v_fmac_f32 v50, v77, v82
    v_fmac_f32 v51, v77, v83
    v_fmac_f32 v52, v77, v84
    v_fmac_f32 v53, v77, v85
    v_fmac_f32 v54, v77, v86
    v_fmac_f32 v55, v77, v87
    v_fmac_f32 v56, v78, v80
    v_fmac_f32 v57, v78, v81
    v_fmac_f32 v58, v78, v82
    v_fmac_f32 v59, v78, v83
    v_fmac_f32 v60, v78, v84
    v_fmac_f32 v61, v78, v85
    v_fmac_f32 v62, v78, v86
    v_fmac_f32 v63, v78, v87
    v_fmac_f32 v64, v79, v80
    v_fmac_f32 v65, v79, v81
    v_fmac_f32 v66, v79, v82
    v_fmac_f32 v67, v79, v83
    v_fmac_f32 v68, v79, v84
    v_fmac_f32 v69, v79, v85
    v_fmac_f32 v70, v79, v86
    v_fmac_f32 v71, v79, v87
    ds_read_b128 v[76:79], v3 offset:2560
    s_waitcnt vmcnt(1)
    v_lshlrev_b32 v80, 16, v120
    v_and_b32 v81, s42, v120
    v_lshlrev_b32 v82, 16, v121
    v_and_b32 v83, s42, v121
    v_lshlrev_b32 v84, 16, v122
    v_and_b32 v85, s42, v122
    v_lshlrev_b32 v86, 16, v123
    v_and_b32 v87, s42, v123
    buffer_load_dwordx4 v[128:131], v2, s[44:47], s11 offen
    s_add_u32 s11, s11, 88064
    s_waitcnt lgkmcnt(1)
    v_fmac_f32 v40, v72, v80
    v_fmac_f32 v41, v72, v81
    v_fmac_f32 v42, v72, v82
    v_fmac_f32 v43, v72, v83
    v_fmac_f32 v44, v72, v84
    v_fmac_f32 v45, v72, v85
    v_fmac_f32 v46, v72, v86
    v_fmac_f32 v47, v72, v87
    v_fmac_f32 v48, v73, v80
    v_fmac_f32 v49, v73, v81
    v_fmac_f32 v50, v73, v82
    v_fmac_f32 v51, v73, v83
    v_fmac_f32 v52, v73, v84
    v_fmac_f32 v53, v73, v85
    v_fmac_f32 v54, v73, v86
    v_fmac_f32 v55, v73, v87
    v_fmac_f32 v56, v74, v80
    v_fmac_f32 v57, v74, v81
    v_fmac_f32 v58, v74, v82
    v_fmac_f32 v59, v74, v83
    v_fmac_f32 v60, v74, v84
    v_fmac_f32 v61, v74, v85
    v_fmac_f32 v62, v74, v86
    v_fmac_f32 v63, v74, v87
    v_fmac_f32 v64, v75, v80
    v_fmac_f32 v65, v75, v81
    v_fmac_f32 v66, v75, v82
    v_fmac_f32 v67, v75, v83
    v_fmac_f32 v68, v75, v84
    v_fmac_f32 v69, v75, v85
    v_fmac_f32 v70, v75, v86
    v_fmac_f32 v71, v75, v87
    ds_read_b128 v[72:75], v3 offset:3072
    s_waitcnt vmcnt(1)
    v_lshlrev_b32 v80, 16, v124
    v_and_b32 v81, s42, v124
    v_lshlrev_b32 v82, 16, v125
    v_and_b32 v83, s42, v125
    v_lshlrev_b32 v84, 16, v126
    v_and_b32 v85, s42, v126
    v_lshlrev_b32 v86, 16, v127
    v_and_b32 v87, s42, v127
    buffer_load_dwordx4 v[132:135], v2, s[44:47], s11 offen
    s_add_u32 s11, s11, 88064
    s_waitcnt lgkmcnt(1)
    v_fmac_f32 v40, v76, v80
    v_fmac_f32 v41, v76, v81
    v_fmac_f32 v42, v76, v82
    v_fmac_f32 v43, v76, v83
    v_fmac_f32 v44, v76, v84
    v_fmac_f32 v45, v76, v85
    v_fmac_f32 v46, v76, v86
    v_fmac_f32 v47, v76, v87
    v_fmac_f32 v48, v77, v80
    v_fmac_f32 v49, v77, v81
    v_fmac_f32 v50, v77, v82
    v_fmac_f32 v51, v77, v83
    v_fmac_f32 v52, v77, v84
    v_fmac_f32 v53, v77, v85
    v_fmac_f32 v54, v77, v86
    v_fmac_f32 v55, v77, v87
    v_fmac_f32 v56, v78, v80
    v_fmac_f32 v57, v78, v81
    v_fmac_f32 v58, v78, v82
    v_fmac_f32 v59, v78, v83
    v_fmac_f32 v60, v78, v84
    v_fmac_f32 v61, v78, v85
    v_fmac_f32 v62, v78, v86
    v_fmac_f32 v63, v78, v87
    v_fmac_f32 v64, v79, v80
    v_fmac_f32 v65, v79, v81
    v_fmac_f32 v66, v79, v82
    v_fmac_f32 v67, v79, v83
    v_fmac_f32 v68, v79, v84
    v_fmac_f32 v69, v79, v85
    v_fmac_f32 v70, v79, v86
    v_fmac_f32 v71, v79, v87
    ds_read_b128 v[76:79], v3 offset:3584
    s_waitcnt vmcnt(1)
    v_lshlrev_b32 v80, 16, v128
    v_and_b32 v81, s42, v128
    v_lshlrev_b32 v82, 16, v129
    v_and_b32 v83, s42, v129
    v_lshlrev_b32 v84, 16, v130
    v_and_b32 v85, s42, v130
    v_lshlrev_b32 v86, 16, v131
    v_and_b32 v87, s42, v131
    buffer_load_dwordx4 v[136:139], v2, s[44:47], s11 offen
    s_add_u32 s11, s11, 88064
    s_waitcnt lgkmcnt(1)
    v_fmac_f32 v40, v72, v80
    v_fmac_f32 v41, v72, v81
    v_fmac_f32 v42, v72, v82
    v_fmac_f32 v43, v72, v83
    v_fmac_f32 v44, v72, v84
    v_fmac_f32 v45, v72, v85
    v_fmac_f32 v46, v72, v86
    v_fmac_f32 v47, v72, v87
    v_fmac_f32 v48, v73, v80
    v_fmac_f32 v49, v73, v81
    v_fmac_f32 v50, v73, v82
    v_fmac_f32 v51, v73, v83
    v_fmac_f32 v52, v73, v84
    v_fmac_f32 v53, v73, v85
    v_fmac_f32 v54, v73, v86
    v_fmac_f32 v55, v73, v87
    v_fmac_f32 v56, v74, v80
    v_fmac_f32 v57, v74, v81
    v_fmac_f32 v58, v74, v82
    v_fmac_f32 v59, v74, v83
    v_fmac_f32 v60, v74, v84
    v_fmac_f32 v61, v74, v85
    v_fmac_f32 v62, v74, v86
    v_fmac_f32 v63, v74, v87
    v_fmac_f32 v64, v75, v80
    v_fmac_f32 v65, v75, v81
    v_fmac_f32 v66, v75, v82
    v_fmac_f32 v67, v75, v83
    v_fmac_f32 v68, v75, v84
    v_fmac_f32 v69, v75, v85
    v_fmac_f32 v70, v75, v86
    v_fmac_f32 v71, v75, v87
    ds_read_b128 v[72:75], v3 offset:4096
    s_waitcnt vmcnt(1)
    v_lshlrev_b32 v80, 16, v132
    v_and_b32 v81, s42, v132
    v_lshlrev_b32 v82, 16, v133
    v_and_b32 v83, s42, v133
    v_lshlrev_b32 v84, 16, v134
    v_and_b32 v85, s42, v134
    v_lshlrev_b32 v86, 16, v135
    v_and_b32 v87, s42, v135
    buffer_load_dwordx4 v[140:143], v2, s[44:47], s11 offen
    s_add_u32 s11, s11, 88064
    s_waitcnt lgkmcnt(1)
    v_fmac_f32 v40, v76, v80
    v_fmac_f32 v41, v76, v81
    v_fmac_f32 v42, v76, v82
    v_fmac_f32 v43, v76, v83
    v_fmac_f32 v44, v76, v84
    v_fmac_f32 v45, v76, v85
    v_fmac_f32 v46, v76, v86
    v_fmac_f32 v47, v76, v87
    v_fmac_f32 v48, v77, v80
    v_fmac_f32 v49, v77, v81
    v_fmac_f32 v50, v77, v82
    v_fmac_f32 v51, v77, v83
    v_fmac_f32 v52, v77, v84
    v_fmac_f32 v53, v77, v85
    v_fmac_f32 v54, v77, v86
    v_fmac_f32 v55, v77, v87
    v_fmac_f32 v56, v78, v80
    v_fmac_f32 v57, v78, v81
    v_fmac_f32 v58, v78, v82
    v_fmac_f32 v59, v78, v83
    v_fmac_f32 v60, v78, v84
    v_fmac_f32 v61, v78, v85
    v_fmac_f32 v62, v78, v86
    v_fmac_f32 v63, v78, v87
    v_fmac_f32 v64, v79, v80
    v_fmac_f32 v65, v79, v81
    v_fmac_f32 v66, v79, v82
    v_fmac_f32 v67, v79, v83
    v_fmac_f32 v68, v79, v84
    v_fmac_f32 v69, v79, v85
    v_fmac_f32 v70, v79, v86
    v_fmac_f32 v71, v79, v87
    ds_read_b128 v[76:79], v3 offset:4608
    s_waitcnt vmcnt(1)
    v_lshlrev_b32 v80, 16, v136
    v_and_b32 v81, s42, v136
    v_lshlrev_b32 v82, 16, v137
    v_and_b32 v83, s42, v137
    v_lshlrev_b32 v84, 16, v138
    v_and_b32 v85, s42, v138
    v_lshlrev_b32 v86, 16, v139
    v_and_b32 v87, s42, v139
    buffer_load_dwordx4 v[144:147], v2, s[44:47], s11 offen
    s_add_u32 s11, s11, 88064
    s_waitcnt lgkmcnt(1)
    v_fmac_f32 v40, v72, v80
    v_fmac_f32 v41, v72, v81
    v_fmac_f32 v42, v72, v82
    v_fmac_f32 v43, v72, v83
    v_fmac_f32 v44, v72, v84
    v_fmac_f32 v45, v72, v85
    v_fmac_f32 v46, v72, v86
    v_fmac_f32 v47, v72, v87
    v_fmac_f32 v48, v73, v80
    v_fmac_f32 v49, v73, v81
    v_fmac_f32 v50, v73, v82
    v_fmac_f32 v51, v73, v83
    v_fmac_f32 v52, v73, v84
    v_fmac_f32 v53, v73, v85
    v_fmac_f32 v54, v73, v86
    v_fmac_f32 v55, v73, v87
    v_fmac_f32 v56, v74, v80
    v_fmac_f32 v57, v74, v81
    v_fmac_f32 v58, v74, v82
    v_fmac_f32 v59, v74, v83
    v_fmac_f32 v60, v74, v84
    v_fmac_f32 v61, v74, v85
    v_fmac_f32 v62, v74, v86
    v_fmac_f32 v63, v74, v87
    v_fmac_f32 v64, v75, v80
    v_fmac_f32 v65, v75, v81
    v_fmac_f32 v66, v75, v82
    v_fmac_f32 v67, v75, v83
    v_fmac_f32 v68, v75, v84
    v_fmac_f32 v69, v75, v85
    v_fmac_f32 v70, v75, v86
    v_fmac_f32 v71, v75, v87
    ds_read_b128 v[72:75], v3 offset:5120
    s_waitcnt vmcnt(1)
    v_lshlrev_b32 v80, 16, v140
    v_and_b32 v81, s42, v140
    v_lshlrev_b32 v82, 16, v141
    v_and_b32 v83, s42, v141
    v_lshlrev_b32 v84, 16, v142
    v_and_b32 v85, s42, v142
    v_lshlrev_b32 v86, 16, v143
    v_and_b32 v87, s42, v143
    buffer_load_dwordx4 v[148:151], v2, s[44:47], s11 offen
    s_add_u32 s11, s11, 88064
    s_waitcnt lgkmcnt(1)
    v_fmac_f32 v40, v76, v80
    v_fmac_f32 v41, v76, v81
    v_fmac_f32 v42, v76, v82
    v_fmac_f32 v43, v76, v83
    v_fmac_f32 v44, v76, v84
    v_fmac_f32 v45, v76, v85
    v_fmac_f32 v46, v76, v86
    v_fmac_f32 v47, v76, v87
    v_fmac_f32 v48, v77, v80
    v_fmac_f32 v49, v77, v81
    v_fmac_f32 v50, v77, v82
    v_fmac_f32 v51, v77, v83
    v_fmac_f32 v52, v77, v84
    v_fmac_f32 v53, v77, v85
    v_fmac_f32 v54, v77, v86
    v_fmac_f32 v55, v77, v87
    v_fmac_f32 v56, v78, v80
    v_fmac_f32 v57, v78, v81
    v_fmac_f32 v58, v78, v82
    v_fmac_f32 v59, v78, v83
    v_fmac_f32 v60, v78, v84
    v_fmac_f32 v61, v78, v85
    v_fmac_f32 v62, v78, v86
    v_fmac_f32 v63, v78, v87
    v_fmac_f32 v64, v79, v80
    v_fmac_f32 v65, v79, v81
    v_fmac_f32 v66, v79, v82
    v_fmac_f32 v67, v79, v83
    v_fmac_f32 v68, v79, v84
    v_fmac_f32 v69, v79, v85
    v_fmac_f32 v70, v79, v86
    v_fmac_f32 v71, v79, v87
    ds_read_b128 v[76:79], v3 offset:5632
    s_waitcnt vmcnt(1)
    v_lshlrev_b32 v80, 16, v144
    v_and_b32 v81, s42, v144
    v_lshlrev_b32 v82, 16, v145
    v_and_b32 v83, s42, v145
    v_lshlrev_b32 v84, 16, v146
    v_and_b32 v85, s42, v146
    v_lshlrev_b32 v86, 16, v147
    v_and_b32 v87, s42, v147
    buffer_load_dwordx4 v[152:155], v2, s[44:47], s11 offen
    s_add_u32 s11, s11, 88064
    s_waitcnt lgkmcnt(1)
    v_fmac_f32 v40, v72, v80
    v_fmac_f32 v41, v72, v81
    v_fmac_f32 v42, v72, v82
    v_fmac_f32 v43, v72, v83
    v_fmac_f32 v44, v72, v84
    v_fmac_f32 v45, v72, v85
    v_fmac_f32 v46, v72, v86
    v_fmac_f32 v47, v72, v87
    v_fmac_f32 v48, v73, v80
    v_fmac_f32 v49, v73, v81
    v_fmac_f32 v50, v73, v82
    v_fmac_f32 v51, v73, v83
    v_fmac_f32 v52, v73, v84
    v_fmac_f32 v53, v73, v85
    v_fmac_f32 v54, v73, v86
    v_fmac_f32 v55, v73, v87
    v_fmac_f32 v56, v74, v80
    v_fmac_f32 v57, v74, v81
    v_fmac_f32 v58, v74, v82
    v_fmac_f32 v59, v74, v83
    v_fmac_f32 v60, v74, v84
    v_fmac_f32 v61, v74, v85
    v_fmac_f32 v62, v74, v86
    v_fmac_f32 v63, v74, v87
    v_fmac_f32 v64, v75, v80
    v_fmac_f32 v65, v75, v81
    v_fmac_f32 v66, v75, v82
    v_fmac_f32 v67, v75, v83
    v_fmac_f32 v68, v75, v84
    v_fmac_f32 v69, v75, v85
    v_fmac_f32 v70, v75, v86
    v_fmac_f32 v71, v75, v87
    ds_read_b128 v[72:75], v3 offset:6144
    s_waitcnt vmcnt(1)
    v_lshlrev_b32 v80, 16, v148
    v_and_b32 v81, s42, v148
    v_lshlrev_b32 v82, 16, v149
    v_and_b32 v83, s42, v149
    v_lshlrev_b32 v84, 16, v150
    v_and_b32 v85, s42, v150
    v_lshlrev_b32 v86, 16, v151
    v_and_b32 v87, s42, v151
    buffer_load_dwordx4 v[156:159], v2, s[44:47], s11 offen
    s_add_u32 s11, s11, 88064
    s_waitcnt lgkmcnt(1)
    v_fmac_f32 v40, v76, v80
    v_fmac_f32 v41, v76, v81
    v_fmac_f32 v42, v76, v82
    v_fmac_f32 v43, v76, v83
    v_fmac_f32 v44, v76, v84
    v_fmac_f32 v45, v76, v85
    v_fmac_f32 v46, v76, v86
    v_fmac_f32 v47, v76, v87
    v_fmac_f32 v48, v77, v80
    v_fmac_f32 v49, v77, v81
    v_fmac_f32 v50, v77, v82
    v_fmac_f32 v51, v77, v83
    v_fmac_f32 v52, v77, v84
    v_fmac_f32 v53, v77, v85
    v_fmac_f32 v54, v77, v86
    v_fmac_f32 v55, v77, v87
    v_fmac_f32 v56, v78, v80
    v_fmac_f32 v57, v78, v81
    v_fmac_f32 v58, v78, v82
    v_fmac_f32 v59, v78, v83
    v_fmac_f32 v60, v78, v84
    v_fmac_f32 v61, v78, v85
    v_fmac_f32 v62, v78, v86
    v_fmac_f32 v63, v78, v87
    v_fmac_f32 v64, v79, v80
    v_fmac_f32 v65, v79, v81
    v_fmac_f32 v66, v79, v82
    v_fmac_f32 v67, v79, v83
    v_fmac_f32 v68, v79, v84
    v_fmac_f32 v69, v79, v85
    v_fmac_f32 v70, v79, v86
    v_fmac_f32 v71, v79, v87
    ds_read_b128 v[76:79], v3 offset:6656
    s_waitcnt vmcnt(1)
    v_lshlrev_b32 v80, 16, v152
    v_and_b32 v81, s42, v152
    v_lshlrev_b32 v82, 16, v153
    v_and_b32 v83, s42, v153
    v_lshlrev_b32 v84, 16, v154
    v_and_b32 v85, s42, v154
    v_lshlrev_b32 v86, 16, v155
    v_and_b32 v87, s42, v155
    buffer_load_dwordx4 v[160:163], v2, s[44:47], s11 offen
    s_add_u32 s11, s11, 88064
    s_waitcnt lgkmcnt(1)
    v_fmac_f32 v40, v72, v80
    v_fmac_f32 v41, v72, v81
    v_fmac_f32 v42, v72, v82
    v_fmac_f32 v43, v72, v83
    v_fmac_f32 v44, v72, v84
    v_fmac_f32 v45, v72, v85
    v_fmac_f32 v46, v72, v86
    v_fmac_f32 v47, v72, v87
    v_fmac_f32 v48, v73, v80
    v_fmac_f32 v49, v73, v81
    v_fmac_f32 v50, v73, v82
    v_fmac_f32 v51, v73, v83
    v_fmac_f32 v52, v73, v84
    v_fmac_f32 v53, v73, v85
    v_fmac_f32 v54, v73, v86
    v_fmac_f32 v55, v73, v87
    v_fmac_f32 v56, v74, v80
    v_fmac_f32 v57, v74, v81
    v_fmac_f32 v58, v74, v82
    v_fmac_f32 v59, v74, v83
    v_fmac_f32 v60, v74, v84
    v_fmac_f32 v61, v74, v85
    v_fmac_f32 v62, v74, v86
    v_fmac_f32 v63, v74, v87
    v_fmac_f32 v64, v75, v80
    v_fmac_f32 v65, v75, v81
    v_fmac_f32 v66, v75, v82
    v_fmac_f32 v67, v75, v83
    v_fmac_f32 v68, v75, v84
    v_fmac_f32 v69, v75, v85
    v_fmac_f32 v70, v75, v86
    v_fmac_f32 v71, v75, v87
    ds_read_b128 v[72:75], v3 offset:7168
    s_waitcnt vmcnt(1)
    v_lshlrev_b32 v80, 16, v156
    v_and_b32 v81, s42, v156
    v_lshlrev_b32 v82, 16, v157
    v_and_b32 v83, s42, v157
    v_lshlrev_b32 v84, 16, v158
    v_and_b32 v85, s42, v158
    v_lshlrev_b32 v86, 16, v159
    v_and_b32 v87, s42, v159
    buffer_load_dwordx4 v[164:167], v2, s[44:47], s11 offen
    s_add_u32 s11, s11, 88064
    s_waitcnt lgkmcnt(1)
    v_fmac_f32 v40, v76, v80
    v_fmac_f32 v41, v76, v81
    v_fmac_f32 v42, v76, v82
    v_fmac_f32 v43, v76, v83
    v_fmac_f32 v44, v76, v84
    v_fmac_f32 v45, v76, v85
    v_fmac_f32 v46, v76, v86
    v_fmac_f32 v47, v76, v87
    v_fmac_f32 v48, v77, v80
    v_fmac_f32 v49, v77, v81
    v_fmac_f32 v50, v77, v82
    v_fmac_f32 v51, v77, v83
    v_fmac_f32 v52, v77, v84
    v_fmac_f32 v53, v77, v85
    v_fmac_f32 v54, v77, v86
    v_fmac_f32 v55, v77, v87
    v_fmac_f32 v56, v78, v80
    v_fmac_f32 v57, v78, v81
    v_fmac_f32 v58, v78, v82
    v_fmac_f32 v59, v78, v83
    v_fmac_f32 v60, v78, v84
    v_fmac_f32 v61, v78, v85
    v_fmac_f32 v62, v78, v86
    v_fmac_f32 v63, v78, v87
    v_fmac_f32 v64, v79, v80
    v_fmac_f32 v65, v79, v81
    v_fmac_f32 v66, v79, v82
    v_fmac_f32 v67, v79, v83
    v_fmac_f32 v68, v79, v84
    v_fmac_f32 v69, v79, v85
    v_fmac_f32 v70, v79, v86
    v_fmac_f32 v71, v79, v87
    ds_read_b128 v[76:79], v3 offset:7680
    s_waitcnt vmcnt(1)
    v_lshlrev_b32 v80, 16, v160
    v_and_b32 v81, s42, v160
    v_lshlrev_b32 v82, 16, v161
    v_and_b32 v83, s42, v161
    v_lshlrev_b32 v84, 16, v162
    v_and_b32 v85, s42, v162
    v_lshlrev_b32 v86, 16, v163
    v_and_b32 v87, s42, v163
    s_mov_b32 s11, s10
    buffer_load_dwordx4 v[104:107], v22, s[48:51], s11 offen
    s_add_u32 s11, s11, s12
    s_waitcnt lgkmcnt(1)
    v_fmac_f32 v40, v72, v80
    v_fmac_f32 v41, v72, v81
    v_fmac_f32 v42, v72, v82
    v_fmac_f32 v43, v72, v83
    v_fmac_f32 v44, v72, v84
    v_fmac_f32 v45, v72, v85
    v_fmac_f32 v46, v72, v86
    v_fmac_f32 v47, v72, v87
    v_fmac_f32 v48, v73, v80
    v_fmac_f32 v49, v73, v81
    v_fmac_f32 v50, v73, v82
    v_fmac_f32 v51, v73, v83
    v_fmac_f32 v52, v73, v84
    v_fmac_f32 v53, v73, v85
    v_fmac_f32 v54, v73, v86
    v_fmac_f32 v55, v73, v87
    v_fmac_f32 v56, v74, v80
    v_fmac_f32 v57, v74, v81
    v_fmac_f32 v58, v74, v82
    v_fmac_f32 v59, v74, v83
    v_fmac_f32 v60, v74, v84
    v_fmac_f32 v61, v74, v85
    v_fmac_f32 v62, v74, v86
    v_fmac_f32 v63, v74, v87
    v_fmac_f32 v64, v75, v80
    v_fmac_f32 v65, v75, v81
    v_fmac_f32 v66, v75, v82
    v_fmac_f32 v67, v75, v83
    v_fmac_f32 v68, v75, v84
    v_fmac_f32 v69, v75, v85
    v_fmac_f32 v70, v75, v86
    v_fmac_f32 v71, v75, v87
    s_waitcnt vmcnt(1)
    v_lshlrev_b32 v80, 16, v164
    v_and_b32 v81, s42, v164
    v_lshlrev_b32 v82, 16, v165
    v_and_b32 v83, s42, v165
    v_lshlrev_b32 v84, 16, v166
    v_and_b32 v85, s42, v166
    v_lshlrev_b32 v86, 16, v167
    v_and_b32 v87, s42, v167
    buffer_load_dwordx4 v[108:111], v22, s[48:51], s11 offen
    s_add_u32 s11, s11, s12
    s_waitcnt lgkmcnt(0)
    v_fmac_f32 v40, v76, v80
    v_fmac_f32 v41, v76, v81
    v_fmac_f32 v42, v76, v82
    v_fmac_f32 v43, v76, v83
    v_fmac_f32 v44, v76, v84
    v_fmac_f32 v45, v76, v85
    v_fmac_f32 v46, v76, v86
    v_fmac_f32 v47, v76, v87
    v_fmac_f32 v48, v77, v80
    v_fmac_f32 v49, v77, v81
    v_fmac_f32 v50, v77, v82
    v_fmac_f32 v51, v77, v83
    v_fmac_f32 v52, v77, v84
    v_fmac_f32 v53, v77, v85
    v_fmac_f32 v54, v77, v86
    v_fmac_f32 v55, v77, v87
    v_fmac_f32 v56, v78, v80
    v_fmac_f32 v57, v78, v81
    v_fmac_f32 v58, v78, v82
    v_fmac_f32 v59, v78, v83
    v_fmac_f32 v60, v78, v84
    v_fmac_f32 v61, v78, v85
    v_fmac_f32 v62, v78, v86
    v_fmac_f32 v63, v78, v87
    v_fmac_f32 v64, v79, v80
    v_fmac_f32 v65, v79, v81
    v_fmac_f32 v66, v79, v82
    v_fmac_f32 v67, v79, v83
    v_fmac_f32 v68, v79, v84
    v_fmac_f32 v69, v79, v85
    v_fmac_f32 v70, v79, v86
    v_fmac_f32 v71, v79, v87
    v_permlane32_swap_b32 v40, v56
    v_permlane32_swap_b32 v41, v57
    v_permlane32_swap_b32 v42, v58
    v_permlane32_swap_b32 v43, v59
    v_permlane32_swap_b32 v44, v60
    v_permlane32_swap_b32 v45, v61
    v_permlane32_swap_b32 v46, v62
    v_permlane32_swap_b32 v47, v63
    v_permlane32_swap_b32 v48, v64
    v_permlane32_swap_b32 v49, v65
    v_permlane32_swap_b32 v50, v66
    v_permlane32_swap_b32 v51, v67
    v_permlane32_swap_b32 v52, v68
    v_permlane32_swap_b32 v53, v69
    v_permlane32_swap_b32 v54, v70
    v_permlane32_swap_b32 v55, v71
    v_add_f32 v40, v40, v56
    v_add_f32 v41, v41, v57
    v_add_f32 v42, v42, v58
    v_add_f32 v43, v43, v59
    v_add_f32 v44, v44, v60
    v_add_f32 v45, v45, v61
    v_add_f32 v46, v46, v62
    v_add_f32 v47, v47, v63
    v_add_f32 v48, v48, v64
    v_add_f32 v49, v49, v65
    v_add_f32 v50, v50, v66
    v_add_f32 v51, v51, v67
    v_add_f32 v52, v52, v68
    v_add_f32 v53, v53, v69
    v_add_f32 v54, v54, v70
    v_add_f32 v55, v55, v71
    v_permlane16_swap_b32 v40, v48
    v_permlane16_swap_b32 v41, v49
    v_permlane16_swap_b32 v42, v50
    v_permlane16_swap_b32 v43, v51
    v_permlane16_swap_b32 v44, v52
    v_permlane16_swap_b32 v45, v53
    v_permlane16_swap_b32 v46, v54
    v_permlane16_swap_b32 v47, v55
    v_add_f32 v40, v40, v48
    v_add_f32 v41, v41, v49
    v_add_f32 v42, v42, v50
    v_add_f32 v43, v43, v51
    v_add_f32 v44, v44, v52
    v_add_f32 v45, v45, v53
    v_add_f32 v46, v46, v54
    v_add_f32 v47, v47, v55
    v_add_f32_dpp v40, v40, v40 row_ror:2 row_mask:0xf bank_mask:0xf
    v_add_f32_dpp v41, v41, v41 row_ror:2 row_mask:0xf bank_mask:0xf
    v_add_f32_dpp v42, v42, v42 row_ror:2 row_mask:0xf bank_mask:0xf
    v_add_f32_dpp v43, v43, v43 row_ror:2 row_mask:0xf bank_mask:0xf
    v_add_f32_dpp v44, v44, v44 row_ror:2 row_mask:0xf bank_mask:0xf
    v_add_f32_dpp v45, v45, v45 row_ror:2 row_mask:0xf bank_mask:0xf
    v_add_f32_dpp v46, v46, v46 row_ror:2 row_mask:0xf bank_mask:0xf
    v_add_f32_dpp v47, v47, v47 row_ror:2 row_mask:0xf bank_mask:0xf
    v_add_f32_dpp v40, v40, v40 row_ror:4 row_mask:0xf bank_mask:0xf
    v_add_f32_dpp v41, v41, v41 row_ror:4 row_mask:0xf bank_mask:0xf
    v_add_f32_dpp v42, v42, v42 row_ror:4 row_mask:0xf bank_mask:0xf
    v_add_f32_dpp v43, v43, v43 row_ror:4 row_mask:0xf bank_mask:0xf
    v_add_f32_dpp v44, v44, v44 row_ror:4 row_mask:0xf bank_mask:0xf
    v_add_f32_dpp v45, v45, v45 row_ror:4 row_mask:0xf bank_mask:0xf
    v_add_f32_dpp v46, v46, v46 row_ror:4 row_mask:0xf bank_mask:0xf
    v_add_f32_dpp v47, v47, v47 row_ror:4 row_mask:0xf bank_mask:0xf
    v_add_f32_dpp v40, v40, v40 row_ror:8 row_mask:0xf bank_mask:0xf
    v_add_f32_dpp v41, v41, v41 row_ror:8 row_mask:0xf bank_mask:0xf
    v_add_f32_dpp v42, v42, v42 row_ror:8 row_mask:0xf bank_mask:0xf
    v_add_f32_dpp v43, v43, v43 row_ror:8 row_mask:0xf bank_mask:0xf
    v_add_f32_dpp v44, v44, v44 row_ror:8 row_mask:0xf bank_mask:0xf
    v_add_f32_dpp v45, v45, v45 row_ror:8 row_mask:0xf bank_mask:0xf
    v_add_f32_dpp v46, v46, v46 row_ror:8 row_mask:0xf bank_mask:0xf
    v_add_f32_dpp v47, v47, v47 row_ror:8 row_mask:0xf bank_mask:0xf
    v_mov_b32 v88, v96
    v_mov_b32 v96, v40
    v_mov_b32 v89, v97
    v_mov_b32 v97, v41
    v_mov_b32 v90, v98
    v_mov_b32 v98, v42
    v_mov_b32 v91, v99
    v_mov_b32 v99, v43
    v_mov_b32 v92, v100
    v_mov_b32 v100, v44
    v_mov_b32 v93, v101
    v_mov_b32 v101, v45
    v_mov_b32 v94, v102
    v_mov_b32 v102, v46
    v_mov_b32 v95, v103
    v_mov_b32 v103, v47
    s_cmp_eq_u32 s9, 1
    s_cbranch_scc1 LF_p2
    s_mov_b32 s9, 1
    s_mov_b32 s44, s48
    s_mov_b32 s45, s49
    s_mov_b32 s48, s32
    s_mov_b32 s49, s33
    s_mov_b32 s50, 0
    v_mov_b32 v22, v1
    s_movk_i32 s12, 1024
    s_lshl_b32 s10, s6, 14
    s_branch LF_pass
LF_p2:
    s_nop 1
    v_cvt_pk_bf16_f32 v88, v88, v88
    v_and_b32 v88, s42, v88
    v_cvt_pk_bf16_f32 v96, v96, v96
    v_and_b32 v96, s42, v96
    v_mul_f32 v88, s69, v88
    v_exp_f32 v88, -v88
    s_nop 0
    v_add_f32 v88, 1.0, v88
    v_rcp_f32 v88, v88
    s_nop 0
    v_cvt_pk_bf16_f32 v88, v88, v88
    v_and_b32 v88, s42, v88
    v_mul_f32 v96, v88, v96
    v_cvt_pk_bf16_f32 v96, v96, v96
    v_and_b32 v96, s42, v96
    v_cvt_pk_bf16_f32 v89, v89, v89
    v_and_b32 v89, s42, v89
    v_cvt_pk_bf16_f32 v97, v97, v97
    v_and_b32 v97, s42, v97
    v_mul_f32 v89, s69, v89
    v_exp_f32 v89, -v89
    s_nop 0
    v_add_f32 v89, 1.0, v89
    v_rcp_f32 v89, v89
    s_nop 0
    v_cvt_pk_bf16_f32 v89, v89, v89
    v_and_b32 v89, s42, v89
    v_mul_f32 v97, v89, v97
    v_cvt_pk_bf16_f32 v97, v97, v97
    v_and_b32 v97, s42, v97
    v_cvt_pk_bf16_f32 v90, v90, v90
    v_and_b32 v90, s42, v90
    v_cvt_pk_bf16_f32 v98, v98, v98
    v_and_b32 v98, s42, v98
    v_mul_f32 v90, s69, v90
    v_exp_f32 v90, -v90
    s_nop 0
    v_add_f32 v90, 1.0, v90
    v_rcp_f32 v90, v90
    s_nop 0
    v_cvt_pk_bf16_f32 v90, v90, v90
    v_and_b32 v90, s42, v90
    v_mul_f32 v98, v90, v98
    v_cvt_pk_bf16_f32 v98, v98, v98
    v_and_b32 v98, s42, v98
    v_cvt_pk_bf16_f32 v91, v91, v91
    v_and_b32 v91, s42, v91
    v_cvt_pk_bf16_f32 v99, v99, v99
    v_and_b32 v99, s42, v99
    v_mul_f32 v91, s69, v91
    v_exp_f32 v91, -v91
    s_nop 0
    v_add_f32 v91, 1.0, v91
    v_rcp_f32 v91, v91
    s_nop 0
    v_cvt_pk_bf16_f32 v91, v91, v91
    v_and_b32 v91, s42, v91
    v_mul_f32 v99, v91, v99
    v_cvt_pk_bf16_f32 v99, v99, v99
    v_and_b32 v99, s42, v99
    v_cvt_pk_bf16_f32 v92, v92, v92
    v_and_b32 v92, s42, v92
    v_cvt_pk_bf16_f32 v100, v100, v100
    v_and_b32 v100, s42, v100
    v_mul_f32 v92, s69, v92
    v_exp_f32 v92, -v92
    s_nop 0
    v_add_f32 v92, 1.0, v92
    v_rcp_f32 v92, v92
    s_nop 0
    v_cvt_pk_bf16_f32 v92, v92, v92
    v_and_b32 v92, s42, v92
    v_mul_f32 v100, v92, v100
    v_cvt_pk_bf16_f32 v100, v100, v100
    v_and_b32 v100, s42, v100
    v_cvt_pk_bf16_f32 v93, v93, v93
    v_and_b32 v93, s42, v93
    v_cvt_pk_bf16_f32 v101, v101, v101
    v_and_b32 v101, s42, v101
    v_mul_f32 v93, s69, v93
    v_exp_f32 v93, -v93
    s_nop 0
    v_add_f32 v93, 1.0, v93
    v_rcp_f32 v93, v93
    s_nop 0
    v_cvt_pk_bf16_f32 v93, v93, v93
    v_and_b32 v93, s42, v93
    v_mul_f32 v101, v93, v101
    v_cvt_pk_bf16_f32 v101, v101, v101
    v_and_b32 v101, s42, v101
    v_cvt_pk_bf16_f32 v94, v94, v94
    v_and_b32 v94, s42, v94
    v_cvt_pk_bf16_f32 v102, v102, v102
    v_and_b32 v102, s42, v102
    v_mul_f32 v94, s69, v94
    v_exp_f32 v94, -v94
    s_nop 0
    v_add_f32 v94, 1.0, v94
    v_rcp_f32 v94, v94
    s_nop 0
    v_cvt_pk_bf16_f32 v94, v94, v94
    v_and_b32 v94, s42, v94
    v_mul_f32 v102, v94, v102
    v_cvt_pk_bf16_f32 v102, v102, v102
    v_and_b32 v102, s42, v102
    v_cvt_pk_bf16_f32 v95, v95, v95
    v_and_b32 v95, s42, v95
    v_cvt_pk_bf16_f32 v103, v103, v103
    v_and_b32 v103, s42, v103
    v_mul_f32 v95, s69, v95
    v_exp_f32 v95, -v95
    s_nop 0
    v_add_f32 v95, 1.0, v95
    v_rcp_f32 v95, v95
    s_nop 0
    v_cvt_pk_bf16_f32 v95, v95, v95
    v_and_b32 v95, s42, v95
    v_mul_f32 v103, v95, v103
    v_cvt_pk_bf16_f32 v103, v103, v103
    v_and_b32 v103, s42, v103
    v_cvt_pk_bf16_f32 v40, v96, v97
    v_cvt_pk_bf16_f32 v41, v98, v99
    v_cvt_pk_bf16_f32 v42, v100, v101
    v_cvt_pk_bf16_f32 v43, v102, v103
    v_lshrrev_b32 v2, 4, v0
    s_movk_i32 s4, 2752
    v_mul_lo_u32 v2, v2, s4
    v_and_b32 v3, 1, v0
    v_lshl_add_u32 v2, v3, 4, v2
    s_lshl_b32 s10, s6, 5
    s_add_u32 s10, s10, 98304
    v_mov_b32 v4, 147528
LF_pz:
    ds_read_b32 v5, v4
    s_waitcnt lgkmcnt(0)
    v_readfirstlane_b32 s4, v5
    s_cmp_eq_u32 s4, 0
    s_cbranch_scc1 LF_pz
    s_mov_b32 s4, 0x00030003
    s_mov_b32 s5, 0x00030003
    s_mov_b64 exec, s[4:5]
    buffer_store_dwordx4 v[40:43], v2, s[60:63], s10 offen sc1
    s_branch LA_end2
LA_st2:
    s_mul_i32 s64, s76, 147456
    s_lshl_b32 s4, s77, 7
    s_add_u32 s64, s64, s4
    s_mul_i32 s65, s76, 288
    s_add_u32 s67, s65, 5504
    s_lshl_b32 s66, s76, 13
    s_lshl_b32 s4, s77, 8
    s_add_u32 s66, s66, s4
    s_mov_b32 s44, s32
    s_mov_b32 s45, s33
    s_mov_b32 s46, 1409024
    s_add_u32 s52, s40, 1146880
    s_addc_u32 s53, s41, 0
    s_movk_i32 s54, 11008
    s_add_u32 s56, s40, 1048576
    s_addc_u32 s57, s41, 0
    s_mov_b32 s58, 81920
    s_mov_b32 s70, 0x05040100
    s_mov_b32 s71, 0x07060302
    v_lshrrev_b32 v20, 3, v0
    v_and_b32 v21, 7, v0
    v_mul_u32_u24 v2, 18432, v20
    v_lshl_add_u32 v2, v21, 4, v2
    v_mul_u32_u24 v3, 36, v20
    v_lshrrev_b32 v22, 4, v0
    v_lshlrev_b32 v4, 11, v22
    v_lshl_add_u32 v4, v21, 5, v4
    v_bfe_u32 v22, v0, 3, 1
    v_lshl_add_u32 v4, v22, 4, v4
    v_mov_b32 v16, 147456
LR_w0:
    s_sleep 32
    ds_read_b32 v17, v16
    s_waitcnt lgkmcnt(0)
    v_readfirstlane_b32 s4, v17
    s_cmp_lt_u32 s4, 56
    s_cbranch_scc1 LR_w0
    buffer_load_dwordx4 v[24:27], v2, s[44:47], s64 offen offset:0
    buffer_load_dwordx4 v[28:31], v2, s[44:47], s64 offen offset:1024
    buffer_load_dwordx4 v[32:35], v2, s[44:47], s64 offen offset:2048
    buffer_load_dwordx4 v[36:39], v2, s[44:47], s64 offen offset:3072
    s_add_u32 s64, s64, 4096
    buffer_load_dwordx4 v[40:43], v2, s[44:47], s64 offen offset:0
    buffer_load_dwordx4 v[44:47], v2, s[44:47], s64 offen offset:1024
    buffer_load_dwordx4 v[48:51], v2, s[44:47], s64 offen offset:2048
    buffer_load_dwordx4 v[52:55], v2, s[44:47], s64 offen offset:3072
    s_add_u32 s64, s64, 4096
    buffer_load_dwordx4 v[56:59], v2, s[44:47], s64 offen offset:0
    buffer_load_dwordx4 v[60:63], v2, s[44:47], s64 offen offset:1024
    buffer_load_dwordx4 v[64:67], v2, s[44:47], s64 offen offset:2048
    buffer_load_dwordx4 v[68:71], v2, s[44:47], s64 offen offset:3072
    s_add_u32 s64, s64, 4096
    buffer_load_dwordx4 v[72:75], v2, s[44:47], s64 offen offset:0
    buffer_load_dwordx4 v[76:79], v2, s[44:47], s64 offen offset:1024
    buffer_load_dwordx4 v[80:83], v2, s[44:47], s64 offen offset:2048
    buffer_load_dwordx4 v[84:87], v2, s[44:47], s64 offen offset:3072
    s_add_u32 s64, s64, 4096
    buffer_load_dwordx4 v[88:91], v2, s[44:47], s64 offen offset:0
    buffer_load_dwordx4 v[92:95], v2, s[44:47], s64 offen offset:1024
    s_mov_b32 s48, s38
    s_mov_b32 s49, s39
    s_movk_i32 s50, 256
    v_lshlrev_b32 v6, 2, v0
    s_mov_b32 s9, 20000
    s_mov_b32 s14, 0x04040404
    s_mov_b32 s15, 0x04040404
    v_mov_b32 v18, 0
LR_cz:
    s_mov_b64 exec, s[14:15]
    buffer_load_dword v18, v6, s[48:51], 0 offen sc1
    s_mov_b64 exec, -1
    s_waitcnt vmcnt(0)
    v_add_u32_dpp v19, v18, v18 row_ror:8 row_mask:0xf bank_mask:0xf
    s_nop 0
    v_readlane_b32 s80, v19, 2
    v_readlane_b32 s81, v19, 18
    v_readlane_b32 s82, v19, 34
    v_readlane_b32 s83, v19, 50
    s_add_u32 s80, s80, s81
    s_add_u32 s82, s82, s83
    s_add_u32 s80, s80, s82
    s_cmp_eq_u32 s80, 256
    s_cbranch_scc1 LR_cokz
    s_sleep 64
    s_sub_u32 s9, s9, 1
    s_cmp_lg_u32 s9, 0
    s_cbranch_scc1 LR_cz
LR_cokz:
    v_perm_b32 v8, v28, v24, s70
    v_perm_b32 v28, v28, v24, s71
    v_perm_b32 v24, v29, v25, s70
    v_perm_b32 v29, v29, v25, s71
    v_perm_b32 v25, v30, v26, s70
    v_perm_b32 v30, v30, v26, s71
    v_perm_b32 v26, v31, v27, s70
    v_perm_b32 v31, v31, v27, s71
    v_perm_b32 v27, v36, v32, s70
    v_perm_b32 v36, v36, v32, s71
    v_perm_b32 v32, v37, v33, s70
    v_perm_b32 v37, v37, v33, s71
    v_perm_b32 v33, v38, v34, s70
    v_perm_b32 v38, v38, v34, s71
    v_perm_b32 v34, v39, v35, s70
    v_perm_b32 v39, v39, v35, s71
    v_perm_b32 v35, v44, v40, s70
    v_perm_b32 v44, v44, v40, s71
    v_perm_b32 v40, v45, v41, s70
    v_perm_b32 v45, v45, v41, s71
    v_perm_b32 v41, v46, v42, s70
    v_perm_b32 v46, v46, v42, s71
    v_perm_b32 v42, v47, v43, s70
    v_perm_b32 v47, v47, v43, s71
    v_perm_b32 v43, v52, v48, s70
    v_perm_b32 v52, v52, v48, s71
    v_perm_b32 v48, v53, v49, s70
    v_perm_b32 v53, v53, v49, s71
    v_perm_b32 v49, v54, v50, s70
    v_perm_b32 v54, v54, v50, s71
    v_perm_b32 v50, v55, v51, s70
    v_perm_b32 v55, v55, v51, s71
    v_perm_b32 v51, v60, v56, s70
    v_perm_b32 v60, v60, v56, s71
    v_perm_b32 v56, v61, v57, s70
    v_perm_b32 v61, v61, v57, s71
    v_perm_b32 v57, v62, v58, s70
    v_perm_b32 v62, v62, v58, s71
    v_perm_b32 v58, v63, v59, s70
    v_perm_b32 v63, v63, v59, s71
    v_perm_b32 v59, v68, v64, s70
    v_perm_b32 v68, v68, v64, s71
    v_perm_b32 v64, v69, v65, s70
    v_perm_b32 v69, v69, v65, s71
    v_perm_b32 v65, v70, v66, s70
    v_perm_b32 v70, v70, v66, s71
    v_perm_b32 v66, v71, v67, s70
    v_perm_b32 v71, v71, v67, s71
    v_perm_b32 v67, v76, v72, s70
    v_perm_b32 v76, v76, v72, s71
    v_perm_b32 v72, v77, v73, s70
    v_perm_b32 v77, v77, v73, s71
    v_perm_b32 v73, v78, v74, s70
    v_perm_b32 v78, v78, v74, s71
    v_perm_b32 v74, v79, v75, s70
    v_perm_b32 v79, v79, v75, s71
    v_perm_b32 v75, v84, v80, s70
    v_perm_b32 v84, v84, v80, s71
    v_perm_b32 v80, v85, v81, s70
    v_perm_b32 v85, v85, v81, s71
    v_perm_b32 v81, v86, v82, s70
    v_perm_b32 v86, v86, v82, s71
    v_perm_b32 v82, v87, v83, s70
    v_perm_b32 v87, v87, v83, s71
    v_perm_b32 v83, v92, v88, s70
    v_perm_b32 v92, v92, v88, s71
    v_perm_b32 v88, v93, v89, s70
    v_perm_b32 v93, v93, v89, s71
    v_perm_b32 v89, v94, v90, s70
    v_perm_b32 v94, v94, v90, s71
    v_perm_b32 v90, v95, v91, s70
    v_perm_b32 v95, v95, v91, s71
    s_mov_b32 s9, 20000
LR_h:
    buffer_load_dwordx4 v[96:99], v3, s[52:55], s65 offen offset:0 sc1
    buffer_load_dwordx4 v[100:103], v3, s[52:55], s65 offen offset:16 sc1
    buffer_load_dword v104, v3, s[52:55], s65 offen offset:32 sc1
    buffer_load_dwordx4 v[106:109], v3, s[52:55], s65 offen offset:2752 sc1
    buffer_load_dwordx4 v[110:113], v3, s[52:55], s65 offen offset:2768 sc1
    buffer_load_dword v114, v3, s[52:55], s65 offen offset:2784 sc1
    buffer_load_dwordx4 v[116:119], v3, s[52:55], s67 offen offset:0 sc1
    buffer_load_dwordx4 v[120:123], v3, s[52:55], s67 offen offset:16 sc1
    buffer_load_dword v124, v3, s[52:55], s67 offen offset:32 sc1
    buffer_load_dwordx4 v[126:129], v3, s[52:55], s67 offen offset:2752 sc1
    buffer_load_dwordx4 v[130:133], v3, s[52:55], s67 offen offset:2768 sc1
    buffer_load_dword v134, v3, s[52:55], s67 offen offset:2784 sc1
    s_sub_u32 s9, s9, 1
    s_waitcnt vmcnt(0)
    v_max3_u32 v22, v96, v97, v98
    v_max3_u32 v23, v99, v100, v101
    v_max3_u32 v22, v22, v102, v103
    v_max3_u32 v23, v23, v104, v106
    v_max3_u32 v22, v22, v107, v108
    v_max3_u32 v23, v23, v109, v110
    v_max3_u32 v22, v22, v111, v112
    v_max3_u32 v23, v23, v113, v114
    v_max3_u32 v22, v22, v116, v117
    v_max3_u32 v23, v23, v118, v119
    v_max3_u32 v22, v22, v120, v121
    v_max3_u32 v23, v23, v122, v123
    v_max3_u32 v22, v22, v124, v126
    v_max3_u32 v23, v23, v127, v128
    v_max3_u32 v22, v22, v129, v130
    v_max3_u32 v23, v23, v131, v132
    v_max3_u32 v22, v22, v133, v134
    v_max_u32 v22, v22, v23
    v_cmp_eq_u32 vcc, -1, v22
    s_cmp_eq_u32 s9, 0
    s_cbranch_scc1 LR_hok
    s_cbranch_vccz LR_hok
    s_sleep 32
    s_branch LR_h
LR_hok:
    v_dot2_f32_bf16 v136, v8, v96, 0
    v_dot2_f32_bf16 v137, v28, v96, 0
    v_dot2_f32_bf16 v138, v24, v96, 0
    v_dot2_f32_bf16 v139, v29, v96, 0
    v_dot2_f32_bf16 v140, v25, v96, 0
    v_dot2_f32_bf16 v141, v30, v96, 0
    v_dot2_f32_bf16 v142, v26, v96, 0
    v_dot2_f32_bf16 v143, v31, v96, 0
    v_dot2_f32_bf16 v144, v8, v106, 0
    v_dot2_f32_bf16 v145, v28, v106, 0
    v_dot2_f32_bf16 v146, v24, v106, 0
    v_dot2_f32_bf16 v147, v29, v106, 0
    v_dot2_f32_bf16 v148, v25, v106, 0
    v_dot2_f32_bf16 v149, v30, v106, 0
    v_dot2_f32_bf16 v150, v26, v106, 0
    v_dot2_f32_bf16 v151, v31, v106, 0
    v_dot2_f32_bf16 v152, v8, v116, 0
    v_dot2_f32_bf16 v153, v28, v116, 0
    v_dot2_f32_bf16 v154, v24, v116, 0
    v_dot2_f32_bf16 v155, v29, v116, 0
    v_dot2_f32_bf16 v156, v25, v116, 0
    v_dot2_f32_bf16 v157, v30, v116, 0
    v_dot2_f32_bf16 v158, v26, v116, 0
    v_dot2_f32_bf16 v159, v31, v116, 0
    v_dot2_f32_bf16 v160, v8, v126, 0
    v_dot2_f32_bf16 v161, v28, v126, 0
    v_dot2_f32_bf16 v162, v24, v126, 0
    v_dot2_f32_bf16 v163, v29, v126, 0
    v_dot2_f32_bf16 v164, v25, v126, 0
    v_dot2_f32_bf16 v165, v30, v126, 0
    v_dot2_f32_bf16 v166, v26, v126, 0
    v_dot2_f32_bf16 v167, v31, v126, 0
    v_dot2_f32_bf16 v136, v27, v97, v136
    v_dot2_f32_bf16 v137, v36, v97, v137
    v_dot2_f32_bf16 v138, v32, v97, v138
    v_dot2_f32_bf16 v139, v37, v97, v139
    v_dot2_f32_bf16 v140, v33, v97, v140
    v_dot2_f32_bf16 v141, v38, v97, v141
    v_dot2_f32_bf16 v142, v34, v97, v142
    v_dot2_f32_bf16 v143, v39, v97, v143
    v_dot2_f32_bf16 v144, v27, v107, v144
    v_dot2_f32_bf16 v145, v36, v107, v145
    v_dot2_f32_bf16 v146, v32, v107, v146
    v_dot2_f32_bf16 v147, v37, v107, v147
    v_dot2_f32_bf16 v148, v33, v107, v148
    v_dot2_f32_bf16 v149, v38, v107, v149
    v_dot2_f32_bf16 v150, v34, v107, v150
    v_dot2_f32_bf16 v151, v39, v107, v151
    v_dot2_f32_bf16 v152, v27, v117, v152
    v_dot2_f32_bf16 v153, v36, v117, v153
    v_dot2_f32_bf16 v154, v32, v117, v154
    v_dot2_f32_bf16 v155, v37, v117, v155
    v_dot2_f32_bf16 v156, v33, v117, v156
    v_dot2_f32_bf16 v157, v38, v117, v157
    v_dot2_f32_bf16 v158, v34, v117, v158
    v_dot2_f32_bf16 v159, v39, v117, v159
    v_dot2_f32_bf16 v160, v27, v127, v160
    v_dot2_f32_bf16 v161, v36, v127, v161
    v_dot2_f32_bf16 v162, v32, v127, v162
    v_dot2_f32_bf16 v163, v37, v127, v163
    v_dot2_f32_bf16 v164, v33, v127, v164
    v_dot2_f32_bf16 v165, v38, v127, v165
    v_dot2_f32_bf16 v166, v34, v127, v166
    v_dot2_f32_bf16 v167, v39, v127, v167
    v_dot2_f32_bf16 v136, v35, v98, v136
    v_dot2_f32_bf16 v137, v44, v98, v137
    v_dot2_f32_bf16 v138, v40, v98, v138
    v_dot2_f32_bf16 v139, v45, v98, v139
    v_dot2_f32_bf16 v140, v41, v98, v140
    v_dot2_f32_bf16 v141, v46, v98, v141
    v_dot2_f32_bf16 v142, v42, v98, v142
    v_dot2_f32_bf16 v143, v47, v98, v143
    v_dot2_f32_bf16 v144, v35, v108, v144
    v_dot2_f32_bf16 v145, v44, v108, v145
    v_dot2_f32_bf16 v146, v40, v108, v146
    v_dot2_f32_bf16 v147, v45, v108, v147
    v_dot2_f32_bf16 v148, v41, v108, v148
    v_dot2_f32_bf16 v149, v46, v108, v149
    v_dot2_f32_bf16 v150, v42, v108, v150
    v_dot2_f32_bf16 v151, v47, v108, v151
    v_dot2_f32_bf16 v152, v35, v118, v152
    v_dot2_f32_bf16 v153, v44, v118, v153
    v_dot2_f32_bf16 v154, v40, v118, v154
    v_dot2_f32_bf16 v155, v45, v118, v155
    v_dot2_f32_bf16 v156, v41, v118, v156
    v_dot2_f32_bf16 v157, v46, v118, v157
    v_dot2_f32_bf16 v158, v42, v118, v158
    v_dot2_f32_bf16 v159, v47, v118, v159
    v_dot2_f32_bf16 v160, v35, v128, v160
    v_dot2_f32_bf16 v161, v44, v128, v161
    v_dot2_f32_bf16 v162, v40, v128, v162
    v_dot2_f32_bf16 v163, v45, v128, v163
    v_dot2_f32_bf16 v164, v41, v128, v164
    v_dot2_f32_bf16 v165, v46, v128, v165
    v_dot2_f32_bf16 v166, v42, v128, v166
    v_dot2_f32_bf16 v167, v47, v128, v167
    v_dot2_f32_bf16 v136, v43, v99, v136
    v_dot2_f32_bf16 v137, v52, v99, v137
    v_dot2_f32_bf16 v138, v48, v99, v138
    v_dot2_f32_bf16 v139, v53, v99, v139
    v_dot2_f32_bf16 v140, v49, v99, v140
    v_dot2_f32_bf16 v141, v54, v99, v141
    v_dot2_f32_bf16 v142, v50, v99, v142
    v_dot2_f32_bf16 v143, v55, v99, v143
    v_dot2_f32_bf16 v144, v43, v109, v144
    v_dot2_f32_bf16 v145, v52, v109, v145
    v_dot2_f32_bf16 v146, v48, v109, v146
    v_dot2_f32_bf16 v147, v53, v109, v147
    v_dot2_f32_bf16 v148, v49, v109, v148
    v_dot2_f32_bf16 v149, v54, v109, v149
    v_dot2_f32_bf16 v150, v50, v109, v150
    v_dot2_f32_bf16 v151, v55, v109, v151
    v_dot2_f32_bf16 v152, v43, v119, v152
    v_dot2_f32_bf16 v153, v52, v119, v153
    v_dot2_f32_bf16 v154, v48, v119, v154
    v_dot2_f32_bf16 v155, v53, v119, v155
    v_dot2_f32_bf16 v156, v49, v119, v156
    v_dot2_f32_bf16 v157, v54, v119, v157
    v_dot2_f32_bf16 v158, v50, v119, v158
    v_dot2_f32_bf16 v159, v55, v119, v159
    v_dot2_f32_bf16 v160, v43, v129, v160
    v_dot2_f32_bf16 v161, v52, v129, v161
    v_dot2_f32_bf16 v162, v48, v129, v162
    v_dot2_f32_bf16 v163, v53, v129, v163
    v_dot2_f32_bf16 v164, v49, v129, v164
    v_dot2_f32_bf16 v165, v54, v129, v165
    v_dot2_f32_bf16 v166, v50, v129, v166
    v_dot2_f32_bf16 v167, v55, v129, v167
    v_dot2_f32_bf16 v136, v51, v100, v136
    v_dot2_f32_bf16 v137, v60, v100, v137
    v_dot2_f32_bf16 v138, v56, v100, v138
    v_dot2_f32_bf16 v139, v61, v100, v139
    v_dot2_f32_bf16 v140, v57, v100, v140
    v_dot2_f32_bf16 v141, v62, v100, v141
    v_dot2_f32_bf16 v142, v58, v100, v142
    v_dot2_f32_bf16 v143, v63, v100, v143
    v_dot2_f32_bf16 v144, v51, v110, v144
    v_dot2_f32_bf16 v145, v60, v110, v145
    v_dot2_f32_bf16 v146, v56, v110, v146
    v_dot2_f32_bf16 v147, v61, v110, v147
    v_dot2_f32_bf16 v148, v57, v110, v148
    v_dot2_f32_bf16 v149, v62, v110, v149
    v_dot2_f32_bf16 v150, v58, v110, v150
    v_dot2_f32_bf16 v151, v63, v110, v151
    v_dot2_f32_bf16 v152, v51, v120, v152
    v_dot2_f32_bf16 v153, v60, v120, v153
    v_dot2_f32_bf16 v154, v56, v120, v154
    v_dot2_f32_bf16 v155, v61, v120, v155
    v_dot2_f32_bf16 v156, v57, v120, v156
    v_dot2_f32_bf16 v157, v62, v120, v157
    v_dot2_f32_bf16 v158, v58, v120, v158
    v_dot2_f32_bf16 v159, v63, v120, v159
    v_dot2_f32_bf16 v160, v51, v130, v160
    v_dot2_f32_bf16 v161, v60, v130, v161
    v_dot2_f32_bf16 v162, v56, v130, v162
    v_dot2_f32_bf16 v163, v61, v130, v163
    v_dot2_f32_bf16 v164, v57, v130, v164
    v_dot2_f32_bf16 v165, v62, v130, v165
    v_dot2_f32_bf16 v166, v58, v130, v166
    v_dot2_f32_bf16 v167, v63, v130, v167
    v_dot2_f32_bf16 v136, v59, v101, v136
    v_dot2_f32_bf16 v137, v68, v101, v137
    v_dot2_f32_bf16 v138, v64, v101, v138
    v_dot2_f32_bf16 v139, v69, v101, v139
    v_dot2_f32_bf16 v140, v65, v101, v140
    v_dot2_f32_bf16 v141, v70, v101, v141
    v_dot2_f32_bf16 v142, v66, v101, v142
    v_dot2_f32_bf16 v143, v71, v101, v143
    v_dot2_f32_bf16 v144, v59, v111, v144
    v_dot2_f32_bf16 v145, v68, v111, v145
    v_dot2_f32_bf16 v146, v64, v111, v146
    v_dot2_f32_bf16 v147, v69, v111, v147
    v_dot2_f32_bf16 v148, v65, v111, v148
    v_dot2_f32_bf16 v149, v70, v111, v149
    v_dot2_f32_bf16 v150, v66, v111, v150
    v_dot2_f32_bf16 v151, v71, v111, v151
    v_dot2_f32_bf16 v152, v59, v121, v152
    v_dot2_f32_bf16 v153, v68, v121, v153
    v_dot2_f32_bf16 v154, v64, v121, v154
    v_dot2_f32_bf16 v155, v69, v121, v155
    v_dot2_f32_bf16 v156, v65, v121, v156
    v_dot2_f32_bf16 v157, v70, v121, v157
    v_dot2_f32_bf16 v158, v66, v121, v158
    v_dot2_f32_bf16 v159, v71, v121, v159
    v_dot2_f32_bf16 v160, v59, v131, v160
    v_dot2_f32_bf16 v161, v68, v131, v161
    v_dot2_f32_bf16 v162, v64, v131, v162
    v_dot2_f32_bf16 v163, v69, v131, v163
    v_dot2_f32_bf16 v164, v65, v131, v164
    v_dot2_f32_bf16 v165, v70, v131, v165
    v_dot2_f32_bf16 v166, v66, v131, v166
    v_dot2_f32_bf16 v167, v71, v131, v167
    v_dot2_f32_bf16 v136, v67, v102, v136
    v_dot2_f32_bf16 v137, v76, v102, v137
    v_dot2_f32_bf16 v138, v72, v102, v138
    v_dot2_f32_bf16 v139, v77, v102, v139
    v_dot2_f32_bf16 v140, v73, v102, v140
    v_dot2_f32_bf16 v141, v78, v102, v141
    v_dot2_f32_bf16 v142, v74, v102, v142
    v_dot2_f32_bf16 v143, v79, v102, v143
    v_dot2_f32_bf16 v144, v67, v112, v144
    v_dot2_f32_bf16 v145, v76, v112, v145
    v_dot2_f32_bf16 v146, v72, v112, v146
    v_dot2_f32_bf16 v147, v77, v112, v147
    v_dot2_f32_bf16 v148, v73, v112, v148
    v_dot2_f32_bf16 v149, v78, v112, v149
    v_dot2_f32_bf16 v150, v74, v112, v150
    v_dot2_f32_bf16 v151, v79, v112, v151
    v_dot2_f32_bf16 v152, v67, v122, v152
    v_dot2_f32_bf16 v153, v76, v122, v153
    v_dot2_f32_bf16 v154, v72, v122, v154
    v_dot2_f32_bf16 v155, v77, v122, v155
    v_dot2_f32_bf16 v156, v73, v122, v156
    v_dot2_f32_bf16 v157, v78, v122, v157
    v_dot2_f32_bf16 v158, v74, v122, v158
    v_dot2_f32_bf16 v159, v79, v122, v159
    v_dot2_f32_bf16 v160, v67, v132, v160
    v_dot2_f32_bf16 v161, v76, v132, v161
    v_dot2_f32_bf16 v162, v72, v132, v162
    v_dot2_f32_bf16 v163, v77, v132, v163
    v_dot2_f32_bf16 v164, v73, v132, v164
    v_dot2_f32_bf16 v165, v78, v132, v165
    v_dot2_f32_bf16 v166, v74, v132, v166
    v_dot2_f32_bf16 v167, v79, v132, v167
    v_dot2_f32_bf16 v136, v75, v103, v136
    v_dot2_f32_bf16 v137, v84, v103, v137
    v_dot2_f32_bf16 v138, v80, v103, v138
    v_dot2_f32_bf16 v139, v85, v103, v139
    v_dot2_f32_bf16 v140, v81, v103, v140
    v_dot2_f32_bf16 v141, v86, v103, v141
    v_dot2_f32_bf16 v142, v82, v103, v142
    v_dot2_f32_bf16 v143, v87, v103, v143
    v_dot2_f32_bf16 v144, v75, v113, v144
    v_dot2_f32_bf16 v145, v84, v113, v145
    v_dot2_f32_bf16 v146, v80, v113, v146
    v_dot2_f32_bf16 v147, v85, v113, v147
    v_dot2_f32_bf16 v148, v81, v113, v148
    v_dot2_f32_bf16 v149, v86, v113, v149
    v_dot2_f32_bf16 v150, v82, v113, v150
    v_dot2_f32_bf16 v151, v87, v113, v151
    v_dot2_f32_bf16 v152, v75, v123, v152
    v_dot2_f32_bf16 v153, v84, v123, v153
    v_dot2_f32_bf16 v154, v80, v123, v154
    v_dot2_f32_bf16 v155, v85, v123, v155
    v_dot2_f32_bf16 v156, v81, v123, v156
    v_dot2_f32_bf16 v157, v86, v123, v157
    v_dot2_f32_bf16 v158, v82, v123, v158
    v_dot2_f32_bf16 v159, v87, v123, v159
    v_dot2_f32_bf16 v160, v75, v133, v160
    v_dot2_f32_bf16 v161, v84, v133, v161
    v_dot2_f32_bf16 v162, v80, v133, v162
    v_dot2_f32_bf16 v163, v85, v133, v163
    v_dot2_f32_bf16 v164, v81, v133, v164
    v_dot2_f32_bf16 v165, v86, v133, v165
    v_dot2_f32_bf16 v166, v82, v133, v166
    v_dot2_f32_bf16 v167, v87, v133, v167
    v_dot2_f32_bf16 v136, v83, v104, v136
    v_dot2_f32_bf16 v137, v92, v104, v137
    v_dot2_f32_bf16 v138, v88, v104, v138
    v_dot2_f32_bf16 v139, v93, v104, v139
    v_dot2_f32_bf16 v140, v89, v104, v140
    v_dot2_f32_bf16 v141, v94, v104, v141
    v_dot2_f32_bf16 v142, v90, v104, v142
    v_dot2_f32_bf16 v143, v95, v104, v143
    v_dot2_f32_bf16 v144, v83, v114, v144
    v_dot2_f32_bf16 v145, v92, v114, v145
    v_dot2_f32_bf16 v146, v88, v114, v146
    v_dot2_f32_bf16 v147, v93, v114, v147
    v_dot2_f32_bf16 v148, v89, v114, v148
    v_dot2_f32_bf16 v149, v94, v114, v149
    v_dot2_f32_bf16 v150, v90, v114, v150
    v_dot2_f32_bf16 v151, v95, v114, v151
    v_dot2_f32_bf16 v152, v83, v124, v152
    v_dot2_f32_bf16 v153, v92, v124, v153
    v_dot2_f32_bf16 v154, v88, v124, v154
    v_dot2_f32_bf16 v155, v93, v124, v155
    v_dot2_f32_bf16 v156, v89, v124, v156
    v_dot2_f32_bf16 v157, v94, v124, v157
    v_dot2_f32_bf16 v158, v90, v124, v158
    v_dot2_f32_bf16 v159, v95, v124, v159
    v_dot2_f32_bf16 v160, v83, v134, v160
    v_dot2_f32_bf16 v161, v92, v134, v161
    v_dot2_f32_bf16 v162, v88, v134, v162
    v_dot2_f32_bf16 v163, v93, v134, v163
    v_dot2_f32_bf16 v164, v89, v134, v164
    v_dot2_f32_bf16 v165, v94, v134, v165
    v_dot2_f32_bf16 v166, v90, v134, v166
    v_dot2_f32_bf16 v167, v95, v134, v167
    v_permlane32_swap_b32 v136, v152
    v_permlane32_swap_b32 v137, v153
    v_permlane32_swap_b32 v138, v154
    v_permlane32_swap_b32 v139, v155
    v_permlane32_swap_b32 v140, v156
    v_permlane32_swap_b32 v141, v157
    v_permlane32_swap_b32 v142, v158
    v_permlane32_swap_b32 v143, v159
    v_permlane32_swap_b32 v144, v160
    v_permlane32_swap_b32 v145, v161
    v_permlane32_swap_b32 v146, v162
    v_permlane32_swap_b32 v147, v163
    v_permlane32_swap_b32 v148, v164
    v_permlane32_swap_b32 v149, v165
    v_permlane32_swap_b32 v150, v166
    v_permlane32_swap_b32 v151, v167
    v_add_f32 v136, v136, v152
    v_add_f32 v137, v137, v153
    v_add_f32 v138, v138, v154
    v_add_f32 v139, v139, v155
    v_add_f32 v140, v140, v156
    v_add_f32 v141, v141, v157
    v_add_f32 v142, v142, v158
    v_add_f32 v143, v143, v159
    v_add_f32 v144, v144, v160
    v_add_f32 v145, v145, v161
    v_add_f32 v146, v146, v162
    v_add_f32 v147, v147, v163
    v_add_f32 v148, v148, v164
    v_add_f32 v149, v149, v165
    v_add_f32 v150, v150, v166
    v_add_f32 v151, v151, v167
    v_permlane16_swap_b32 v136, v144
    v_permlane16_swap_b32 v137, v145
    v_permlane16_swap_b32 v138, v146
    v_permlane16_swap_b32 v139, v147
    v_permlane16_swap_b32 v140, v148
    v_permlane16_swap_b32 v141, v149
    v_permlane16_swap_b32 v142, v150
    v_permlane16_swap_b32 v143, v151
    v_add_f32 v136, v136, v144
    v_add_f32 v137, v137, v145
    v_add_f32 v138, v138, v146
    v_add_f32 v139, v139, v147
    v_add_f32 v140, v140, v148
    v_add_f32 v141, v141, v149
    v_add_f32 v142, v142, v150
    v_add_f32 v143, v143, v151
    v_add_f32_dpp v144, v136, v136 row_ror:8 row_mask:0xf bank_mask:0x3
    v_add_f32_dpp v144, v140, v140 row_ror:8 row_mask:0xf bank_mask:0xc
    v_add_f32_dpp v145, v137, v137 row_ror:8 row_mask:0xf bank_mask:0x3
    v_add_f32_dpp v145, v141, v141 row_ror:8 row_mask:0xf bank_mask:0xc
    v_add_f32_dpp v146, v138, v138 row_ror:8 row_mask:0xf bank_mask:0x3
    v_add_f32_dpp v146, v142, v142 row_ror:8 row_mask:0xf bank_mask:0xc
    v_add_f32_dpp v147, v139, v139 row_ror:8 row_mask:0xf bank_mask:0x3
    v_add_f32_dpp v147, v143, v143 row_ror:8 row_mask:0xf bank_mask:0xc
LR_pz:
    ds_read_b32 v17, v16 offset:72
    s_waitcnt lgkmcnt(0)
    v_readfirstlane_b32 s4, v17
    s_cmp_eq_u32 s4, 0
    s_cbranch_scc1 LR_pz
    buffer_store_dwordx4 v[144:147], v4, s[56:59], s66 offen sc1
    s_branch LA_end2
LA_red:
    s_lshr_b32 s7, s5, 4
    s_and_b32 s8, s5, 15
    s_mov_b32 s44, s40
    s_mov_b32 s45, s41
    s_mov_b32 s46, 1130496
    s_mov_b32 s52, s16
    s_mov_b32 s53, s17
    s_movk_i32 s54, 4096
    s_mov_b32 s56, s34
    s_mov_b32 s57, s35
    s_movk_i32 s58, 1024
    s_mov_b32 s60, s36
    s_mov_b32 s61, s37
    s_movk_i32 s62, 4096
    v_lshrrev_b32 v20, 3, v0
    v_and_b32 v21, 7, v0
    v_lshlrev_b32 v3, 11, v20
    v_lshl_add_u32 v3, v21, 4, v3
    v_lshlrev_b32 v5, 13, v20
    v_lshl_add_u32 v5, v21, 4, v5
    v_lshrrev_b32 v22, 4, v0
    v_and_b32 v23, 1, v22
    v_lshlrev_b32 v23, 1, v23
    v_lshrrev_b32 v22, 1, v22
    v_or_b32 v23, v23, v22
    v_lshl_add_u32 v23, v21, 2, v23
    v_lshlrev_b32 v4, 1, v23
    v_mov_b32 v16, 147456
    s_lshl_b32 s4, s7, 17
    s_lshl_b32 s5, s8, 7
    s_add_u32 s64, s4, s5
    s_add_u32 s65, s64, 16384
    s_add_u32 s66, s65, 16384
    s_add_u32 s67, s66, 16384
    s_add_u32 s70, s67, 16384
    s_add_u32 s71, s70, 16384
    s_add_u32 s72, s71, 16384
    s_add_u32 s73, s72, 16384
    s_lshl_b32 s12, s7, 11
    s_add_u32 s12, s12, s5
    s_add_u32 s12, s12, 1048576
    s_add_u32 s11, s12, 65536
    s_lshl_b32 s74, s7, 10
    s_lshl_b32 s5, s8, 6
    s_add_u32 s13, s74, s5
    s_sub_u32 s10, s79, 12
LR_w1:
    s_sleep 32
    ds_read_b32 v17, v16
    s_waitcnt lgkmcnt(0)
    v_readfirstlane_b32 s4, v17
    s_cmp_lt_u32 s4, s10
    s_cbranch_scc1 LR_w1
    buffer_load_dwordx4 v[24:27], v1, s[52:55], s74 offen
    buffer_load_dwordx4 v[28:31], v1, s[56:59], 0 offen
    s_mov_b32 s48, s38
    s_mov_b32 s49, s39
    s_movk_i32 s50, 256
    v_lshlrev_b32 v6, 2, v0
    s_mov_b32 s9, 20000
    s_mov_b32 s14, 0x04040404
    s_mov_b32 s15, 0x04040404
    v_mov_b32 v18, 0
LR_ca:
    s_mov_b64 exec, s[14:15]
    buffer_load_dword v18, v6, s[48:51], 0 offen sc1
    s_mov_b64 exec, -1
    s_waitcnt vmcnt(0)
    v_add_u32_dpp v19, v18, v18 row_ror:8 row_mask:0xf bank_mask:0xf
    s_nop 0
    v_readlane_b32 s80, v19, 2
    v_readlane_b32 s81, v19, 18
    v_readlane_b32 s82, v19, 34
    v_readlane_b32 s83, v19, 50
    s_add_u32 s80, s80, s81
    s_add_u32 s82, s82, s83
    s_add_u32 s80, s80, s82
    s_cmp_eq_u32 s80, 256
    s_cbranch_scc1 LR_coka
    s_sleep 64
    s_sub_u32 s9, s9, 1
    s_cmp_lg_u32 s9, 0
    s_cbranch_scc1 LR_ca
LR_coka:
    s_mov_b32 s9, 20000
LR_s:
    buffer_load_dwordx4 v[72:75], v5, s[44:47], s12 offen sc1
    buffer_load_dwordx4 v[76:79], v5, s[44:47], s11 offen sc1
    s_sub_u32 s9, s9, 1
    s_waitcnt vmcnt(0)
    v_max3_u32 v22, v72, v73, v74
    v_max3_u32 v23, v75, v76, v77
    v_max3_u32 v22, v22, v78, v79
    v_max_u32 v22, v22, v23
    v_cmp_eq_u32 vcc, -1, v22
    s_cmp_eq_u32 s9, 0
    s_cbranch_scc1 LR_sok
    s_cbranch_vccz LR_sok
    s_sleep 32
    s_branch LR_s
LR_sok:
    v_lshlrev_b32 v32, 16, v24
    v_and_b32 v33, s42, v24
    v_lshlrev_b32 v8, 16, v28
    v_and_b32 v9, s42, v28
    v_lshlrev_b32 v34, 16, v25
    v_and_b32 v35, s42, v25
    v_lshlrev_b32 v10, 16, v29
    v_and_b32 v11, s42, v29
    v_lshlrev_b32 v36, 16, v26
    v_and_b32 v37, s42, v26
    v_lshlrev_b32 v12, 16, v30
    v_and_b32 v13, s42, v30
    v_lshlrev_b32 v38, 16, v27
    v_and_b32 v39, s42, v27
    v_lshlrev_b32 v14, 16, v31
    v_and_b32 v15, s42, v31
    v_mul_f32 v32, v32, v8
    v_mul_f32 v33, v33, v9
    v_mul_f32 v34, v34, v10
    v_mul_f32 v35, v35, v11
    v_mul_f32 v36, v36, v12
    v_mul_f32 v37, v37, v13
    v_mul_f32 v38, v38, v14
    v_mul_f32 v39, v39, v15
    v_cvt_pk_bf16_f32 v32, v32, v32
    v_and_b32 v32, s42, v32
    v_cvt_pk_bf16_f32 v33, v33, v33
    v_and_b32 v33, s42, v33
    v_cvt_pk_bf16_f32 v34, v34, v34
    v_and_b32 v34, s42, v34
    v_cvt_pk_bf16_f32 v35, v35, v35
    v_and_b32 v35, s42, v35
    v_cvt_pk_bf16_f32 v36, v36, v36
    v_and_b32 v36, s42, v36
    v_cvt_pk_bf16_f32 v37, v37, v37
    v_and_b32 v37, s42, v37
    v_cvt_pk_bf16_f32 v38, v38, v38
    v_and_b32 v38, s42, v38
    v_cvt_pk_bf16_f32 v39, v39, v39
    v_and_b32 v39, s42, v39
    v_add_f32 v32, v32, v33
    v_add_f32 v34, v34, v35
    v_add_f32 v36, v36, v37
    v_add_f32 v38, v38, v39
    v_add_f32 v32, v32, v34
    v_add_f32 v36, v36, v38
    v_add_f32 v32, v32, v36
    s_nop 1
    v_add_f32_dpp v32, v32, v32 row_ror:1 row_mask:0xf bank_mask:0xf
    s_nop 1
    v_add_f32_dpp v32, v32, v32 row_ror:2 row_mask:0xf bank_mask:0xf
    s_nop 1
    v_add_f32_dpp v32, v32, v32 row_ror:4 row_mask:0xf bank_mask:0xf
    s_nop 1
    v_add_f32_dpp v32, v32, v32 row_ror:8 row_mask:0xf bank_mask:0xf
    s_nop 0
    v_readlane_b32 s80, v32, 0
    v_readlane_b32 s81, v32, 16
    v_readlane_b32 s82, v32, 32
    v_readlane_b32 s83, v32, 48
    v_mov_b32 v32, s80
    v_add_f32 v32, s81, v32
    v_add_f32 v32, s82, v32
    v_add_f32 v32, s83, v32
    v_cvt_pk_bf16_f32 v32, v32, v32
    v_and_b32 v32, s42, v32
    v_mul_f32 v32, s69, v32
    v_exp_f32 v32, -v32
    s_nop 0
    v_add_f32 v32, 1.0, v32
    v_rcp_f32 v32, v32
    s_nop 0
    v_cvt_pk_bf16_f32 v32, v32, v32
    v_and_b32 v32, s42, v32
    v_sub_f32 v33, 1.0, v32
    v_cvt_pk_bf16_f32 v33, v33, v33
    v_and_b32 v33, s42, v33
    v_add_f32 v72, v72, v76
    v_add_f32 v73, v73, v77
    v_add_f32 v74, v74, v78
    v_add_f32 v75, v75, v79
    v_mov_b32 v40, -1
    v_mov_b32 v41, -1
    v_mov_b32 v42, -1
    v_mov_b32 v43, -1
    v_mov_b32 v44, -1
    v_mov_b32 v45, -1
    v_mov_b32 v46, -1
    v_mov_b32 v47, -1
    v_mov_b32 v48, -1
    v_mov_b32 v49, -1
    v_mov_b32 v50, -1
    v_mov_b32 v51, -1
    v_mov_b32 v52, -1
    v_mov_b32 v53, -1
    v_mov_b32 v54, -1
    v_mov_b32 v55, -1
    v_mov_b32 v56, -1
    v_mov_b32 v57, -1
    v_mov_b32 v58, -1
    v_mov_b32 v59, -1
    v_mov_b32 v60, -1
    v_mov_b32 v61, -1
    v_mov_b32 v62, -1
    v_mov_b32 v63, -1
    v_mov_b32 v64, -1
    v_mov_b32 v65, -1
    v_mov_b32 v66, -1
    v_mov_b32 v67, -1
    v_mov_b32 v68, -1
    v_mov_b32 v69, -1
    v_mov_b32 v70, -1
    v_mov_b32 v71, -1
    s_mov_b64 s[16:17], -1
    s_mov_b64 s[18:19], -1
    s_mov_b64 s[20:21], -1
    s_mov_b64 s[22:23], -1
    s_mov_b64 s[24:25], -1
    s_mov_b64 s[26:27], -1
    s_mov_b64 s[28:29], -1
    s_mov_b64 s[30:31], -1
    s_mov_b32 s36, 0x00ff00ff
    s_mov_b32 s37, 0x00ff00ff
    v_permlane32_swap_b32 v72, v73
    v_permlane32_swap_b32 v74, v75
    v_add_f32 v72, v72, v73
    v_add_f32 v74, v74, v75
    s_nop 1
    v_permlane16_swap_b32 v72, v74
    v_add_f32 v72, v72, v74
    s_nop 1
    v_add_f32_dpp v72, v72, v72 row_ror:8 row_mask:0xf bank_mask:0xf
    v_cvt_pk_bf16_f32 v72, v72, v72
    v_and_b32 v72, s42, v72
    v_mul_f32 v33, v33, v72
    v_cvt_pk_bf16_f32 v33, v33, v33
    v_and_b32 v33, s42, v33
    s_sub_u32 s10, s79, 0
    s_mov_b32 s80, 0x0c0c0400
    s_mov_b32 s81, 0x04000c0c
LR_w2:
    s_sleep 4
    ds_read_b32 v17, v16
    s_waitcnt lgkmcnt(0)
    v_readfirstlane_b32 s4, v17
    s_cmp_lt_u32 s4, s10
    s_cbranch_scc1 LR_w2
    s_mov_b32 s9, 20000
LR_p:
    s_or_b64 exec, s[16:17], 1
    buffer_load_dwordx4 v[40:43], v3, s[44:47], s64 offen sc1
    s_or_b64 exec, s[18:19], 1
    buffer_load_dwordx4 v[44:47], v3, s[44:47], s65 offen sc1
    s_or_b64 exec, s[20:21], 1
    buffer_load_dwordx4 v[48:51], v3, s[44:47], s66 offen sc1
    s_or_b64 exec, s[22:23], 1
    buffer_load_dwordx4 v[52:55], v3, s[44:47], s67 offen sc1
    s_or_b64 exec, s[24:25], 1
    buffer_load_dwordx4 v[56:59], v3, s[44:47], s70 offen sc1
    s_or_b64 exec, s[26:27], 1
    buffer_load_dwordx4 v[60:63], v3, s[44:47], s71 offen sc1
    s_or_b64 exec, s[28:29], 1
    buffer_load_dwordx4 v[64:67], v3, s[44:47], s72 offen sc1
    s_or_b64 exec, s[30:31], 1
    buffer_load_dwordx4 v[68:71], v3, s[44:47], s73 offen sc1
    s_mov_b64 exec, -1
    s_sub_u32 s9, s9, 1
    s_mov_b64 s[34:35], 0
    s_waitcnt vmcnt(6)
    v_perm_b32 v120, v41, v40, s80
    v_perm_b32 v128, v43, v42, s81
    v_perm_b32 v121, v45, v44, s80
    v_perm_b32 v129, v47, v46, s81
    v_or_b32 v120, v120, v128
    v_or_b32 v121, v121, v129
    v_max3_u32 v38, v40, v41, v42
    v_max3_u32 v39, v44, v45, v46
    v_sub_f32_dpp v128, v120, v120 row_ror:8 row_mask:0xf bank_mask:0xf
    v_sub_f32_dpp v129, v121, v121 row_ror:8 row_mask:0xf bank_mask:0xf
    v_max_u32 v38, v38, v43
    v_max_u32 v39, v39, v47
    v_exp_f32 v128, v128
    v_exp_f32 v129, v129
    v_cmp_eq_u32 s[16:17], -1, v38
    v_cmp_eq_u32 s[18:19], -1, v39
    v_add_f32 v128, 1.0, v128
    v_add_f32 v129, 1.0, v129
    v_rcp_f32 v128, v128
    v_rcp_f32 v129, v129
    s_or_b64 s[34:35], s[34:35], s[16:17]
    s_or_b64 s[34:35], s[34:35], s[18:19]
    v_mul_f32 v8, v128, v40
    v_mul_f32 v9, v128, v41
    v_mul_f32 v10, v128, v42
    v_mul_f32 v11, v128, v43
    v_mul_f32 v12, v129, v44
    v_mul_f32 v13, v129, v45
    v_mul_f32 v14, v129, v46
    v_mul_f32 v15, v129, v47
    s_waitcnt vmcnt(4)
    v_perm_b32 v122, v49, v48, s80
    v_perm_b32 v130, v51, v50, s81
    v_perm_b32 v123, v53, v52, s80
    v_perm_b32 v131, v55, v54, s81
    v_or_b32 v122, v122, v130
    v_or_b32 v123, v123, v131
    v_max3_u32 v38, v48, v49, v50
    v_max3_u32 v39, v52, v53, v54
    v_sub_f32_dpp v130, v122, v122 row_ror:8 row_mask:0xf bank_mask:0xf
    v_sub_f32_dpp v131, v123, v123 row_ror:8 row_mask:0xf bank_mask:0xf
    v_max_u32 v38, v38, v51
    v_max_u32 v39, v39, v55
    v_exp_f32 v130, v130
    v_exp_f32 v131, v131
    v_cmp_eq_u32 s[20:21], -1, v38
    v_cmp_eq_u32 s[22:23], -1, v39
    v_add_f32 v130, 1.0, v130
    v_add_f32 v131, 1.0, v131
    v_rcp_f32 v130, v130
    v_rcp_f32 v131, v131
    s_or_b64 s[34:35], s[34:35], s[20:21]
    s_or_b64 s[34:35], s[34:35], s[22:23]
    v_fmac_f32 v8, v130, v48
    v_fmac_f32 v9, v130, v49
    v_fmac_f32 v10, v130, v50
    v_fmac_f32 v11, v130, v51
    v_fmac_f32 v12, v131, v52
    v_fmac_f32 v13, v131, v53
    v_fmac_f32 v14, v131, v54
    v_fmac_f32 v15, v131, v55
    s_waitcnt vmcnt(2)
    v_perm_b32 v124, v57, v56, s80
    v_perm_b32 v132, v59, v58, s81
    v_perm_b32 v125, v61, v60, s80
    v_perm_b32 v133, v63, v62, s81
    v_or_b32 v124, v124, v132
    v_or_b32 v125, v125, v133
    v_max3_u32 v38, v56, v57, v58
    v_max3_u32 v39, v60, v61, v62
    v_sub_f32_dpp v132, v124, v124 row_ror:8 row_mask:0xf bank_mask:0xf
    v_sub_f32_dpp v133, v125, v125 row_ror:8 row_mask:0xf bank_mask:0xf
    v_max_u32 v38, v38, v59
    v_max_u32 v39, v39, v63
    v_exp_f32 v132, v132
    v_exp_f32 v133, v133
    v_cmp_eq_u32 s[24:25], -1, v38
    v_cmp_eq_u32 s[26:27], -1, v39
    v_add_f32 v132, 1.0, v132
    v_add_f32 v133, 1.0, v133
    v_rcp_f32 v132, v132
    v_rcp_f32 v133, v133
    s_or_b64 s[34:35], s[34:35], s[24:25]
    s_or_b64 s[34:35], s[34:35], s[26:27]
    v_fmac_f32 v8, v132, v56
    v_fmac_f32 v9, v132, v57
    v_fmac_f32 v10, v132, v58
    v_fmac_f32 v11, v132, v59
    v_fmac_f32 v12, v133, v60
    v_fmac_f32 v13, v133, v61
    v_fmac_f32 v14, v133, v62
    v_fmac_f32 v15, v133, v63
    s_waitcnt vmcnt(0)
    v_perm_b32 v126, v65, v64, s80
    v_perm_b32 v134, v67, v66, s81
    v_perm_b32 v127, v69, v68, s80
    v_perm_b32 v135, v71, v70, s81
    v_or_b32 v126, v126, v134
    v_or_b32 v127, v127, v135
    v_max3_u32 v38, v64, v65, v66
    v_max3_u32 v39, v68, v69, v70
    v_sub_f32_dpp v134, v126, v126 row_ror:8 row_mask:0xf bank_mask:0xf
    v_sub_f32_dpp v135, v127, v127 row_ror:8 row_mask:0xf bank_mask:0xf
    v_max_u32 v38, v38, v67
    v_max_u32 v39, v39, v71
    v_exp_f32 v134, v134
    v_exp_f32 v135, v135
    v_cmp_eq_u32 s[28:29], -1, v38
    v_cmp_eq_u32 s[30:31], -1, v39
    v_add_f32 v134, 1.0, v134
    v_add_f32 v135, 1.0, v135
    v_rcp_f32 v134, v134
    v_rcp_f32 v135, v135
    s_or_b64 s[34:35], s[34:35], s[28:29]
    s_or_b64 s[34:35], s[34:35], s[30:31]
    v_fmac_f32 v8, v134, v64
    v_fmac_f32 v9, v134, v65
    v_fmac_f32 v10, v134, v66
    v_fmac_f32 v11, v134, v67
    v_fmac_f32 v12, v135, v68
    v_fmac_f32 v13, v135, v69
    v_fmac_f32 v14, v135, v70
    v_fmac_f32 v15, v135, v71
    v_add_f32 v8, v8, v12
    v_add_f32 v9, v9, v13
    v_add_f32 v10, v10, v14
    v_add_f32 v11, v11, v15
    s_cmp_eq_u32 s9, 0
    s_cselect_b64 s[34:35], 0, s[34:35]
    v_permlane32_swap_b32 v8, v9
    v_permlane32_swap_b32 v10, v11
    v_add_f32 v8, v8, v9
    v_add_f32 v10, v10, v11
    s_nop 1
    v_permlane16_swap_b32 v8, v10
    v_add_f32 v8, v8, v10
    s_nop 1
    v_add_f32_dpp v8, v8, v8 row_ror:8 row_mask:0xf bank_mask:0xf
    s_cmp_eq_u64 s[34:35], 0
    s_cselect_b64 s[38:39], s[36:37], 0
    v_cvt_pk_bf16_f32 v8, v8, v8
    v_and_b32 v8, s42, v8
    v_mul_f32 v8, v32, v8
    v_cvt_pk_bf16_f32 v8, v8, v8
    v_and_b32 v8, s42, v8
    v_add_f32 v8, v8, v33
    v_cvt_pk_bf16_f32 v8, v8, v8
    s_mov_b64 exec, s[38:39]
    buffer_store_short v8, v4, s[60:63], s13 offen
    s_cbranch_scc0 LR_p
    s_mov_b64 exec, -1
    s_branch LA_end2
LA_end:
    s_endpgm
LB_end:
    s_endpgm
.section .rodata,"a"
.p2align 6
.amdhsa_kernel attn_kernel
  .amdhsa_next_free_vgpr 168
  .amdhsa_next_free_sgpr 100
  .amdhsa_accum_offset 168
  .amdhsa_group_segment_fixed_size 0
  .amdhsa_kernarg_size 104
  .amdhsa_user_sgpr_count 2
  .amdhsa_user_sgpr_kernarg_segment_ptr 1
  .amdhsa_system_sgpr_workgroup_id_x 1
.end_amdhsa_kernel
```
